```python
import torch

def _softmax(x, axis=-1):
    return torch.softmax(x, dim=axis)
def _gelu(x):
    return torch.nn.functional.gelu(x, approximate="tanh")
def _silu(x):
    return torch.nn.functional.silu(x)
def _sigmoid(x):
    return torch.sigmoid(x)
def _layernorm(x, axis=-1, eps=1e-5):
    m = x.mean(dim=axis, keepdim=True)
    v = x.var(dim=axis, keepdim=True, unbiased=False)
    return (x - m) / torch.sqrt(v + eps)
def _scatter_add(tgt, idx, src, axis=0):
    return tgt.clone().index_add_(axis, idx, src)
def _segment_sum(src, seg, n):
    out = torch.zeros((n,) + src.shape[1:], dtype=src.dtype)
    return out.index_add_(0, seg, src)
def _pad(x, pw):
    flat = tuple(v for pair in reversed(pw) for v in pair)
    return torch.nn.functional.pad(x, flat)

kernel_name = 'standalone__cross_network_dcn_v2__recsys'

def setup_inputs():

    _w = (lambda a: (lambda t: t.to(torch.bfloat16) if t.is_floating_point() else t)(torch.as_tensor(a)))
    B, F, D, L = 16384, 100, 16, 3
    Din = min(F * D, 512)
    R = max(Din // 4, 2)
    sc = Din ** -0.5
    return {
        "x0": _w((lambda *s: torch.randn(*s, dtype=torch.bfloat16) * 0.05)(B, Din)),
        "U":  _w((lambda *s: torch.randn(*s, dtype=torch.bfloat16) * 1.6)(L, Din, R) * sc),
        "V":  _w((lambda *s: torch.randn(*s, dtype=torch.bfloat16) * 1.6)(L, R, Din) * sc),
        "bs": _w((lambda *s: torch.randn(*s, dtype=torch.bfloat16) * 0.05)(L, Din)),
    }

def reference(x0, U, V, bs):
    x = x0
    for l in range(U.shape[0]):
        h = torch.einsum('rd,bd->br', V[l], x)
        h = torch.einsum('dr,br->bd', U[l], h)
        x = x0 * (h + bs[l]) + x
    return x
```

```asm
; @launch grid=(256,1,1) block=(256,1,1) lds=163840
.amdgcn_target "amdgcn-amd-amdhsa--gfx950"
.text
.globl standalone__cross_network_dcn_v2__recsys_kernel
.p2align 12
.p2align 8
.type standalone__cross_network_dcn_v2__recsys_kernel,@function
standalone__cross_network_dcn_v2__recsys_kernel:
    s_cmp_ge_u32 s2, 256
    s_cbranch_scc1 L_END
    s_load_dwordx8 s[48:55], s[0:1], 0
    s_load_dwordx4 s[56:59], s[0:1], 32
    s_load_dwordx2 s[60:61], s[0:1], 48
    s_getpc_b64 s[76:77]
L_PC:
    s_lshl_b32 s3, s2, 4
    s_and_b32 s3, s3, 1920
    v_lshl_add_u32 v3, v0, 11, s3
    v_min_u32 v3, L_END-L_PC, v3
    v_mad_u64_u32 v[10:11], vcc, v3, 1, s[76:77]
    global_load_dword a252, v[10:11], off
    v_lshrrev_b32 v2, 6, v0
    v_and_b32 v1, 63, v0
    v_readfirstlane_b32 s28, v2
    v_lshrrev_b32 v3, 3, v1
    v_and_b32 v4, 7, v1
    v_lshrrev_b32 v5, 4, v1
    v_xor_b32 v6, v4, v5
    v_lshlrev_b32 v6, 4, v6
    v_lshl_add_u32 v16, v3, 10, v6
    v_xor_b32 v17, 64, v16
    v_add_u32 v17, 7168, v17
    v_and_b32 v4, 4, v3
    v_add_u32 v3, v3, v4
    v_lshl_add_u32 v18, v3, 10, v6
    v_xor_b32 v19, 64, v18
    v_add_u32 v19, 15360, v19
    v_lshl_add_u32 v28, v3, 8, v6
    v_and_b32 v7, 15, v1
    v_and_b32 v8, 12, v1
    v_add_u32 v8, v8, v7
    s_lshl_b32 s3, s2, 16
    s_lshl_b32 s31, s28, 8
    s_add_u32 s3, s3, s31
    s_mul_i32 s32, s28, 40960
    s_mul_i32 s36, s28, 33024
    s_lshr_b32 s31, s2, 3
    s_lshl_b32 s31, s31, 2
    s_add_u32 s31, s31, s28
    s_lshl_b32 s31, s31, 10
    v_and_b32 v4, 7, v1
    v_lshl_add_u32 v4, v4, 7, s31
    s_mov_b32 s10, 65536
    s_mov_b32 s11, 0x20000
    s_mov_b32 s14, 262144
    s_mov_b32 s15, 0x20000
    s_mov_b32 s18, 393216
    s_mov_b32 s19, 0x20000
    s_and_b32 s63, s2, 7
    s_lshl_b32 s63, s63, 3
    s_lshr_b32 s64, s2, 3
    s_mov_b32 s72, 0xc101010
    s_mov_b32 s73, 0x100000
    s_lshr_b64 s[72:73], s[72:73], s63
    s_and_b32 s62, s72, 0xff
    s_mov_b32 s72, 0x30201000
    s_mov_b32 s73, 0x4c3c3c3c
    s_lshr_b64 s[72:73], s[72:73], s63
    s_and_b32 s74, s72, 0xff
    s_add_u32 s74, s74, s64
    s_cmp_ge_u32 s64, s62
    s_cselect_b32 s74, 255, s74
    s_and_b32 s63, s74, 3
    s_lshr_b32 s64, s74, 2
    s_lshl_b32 s64, s64, 1
    s_cmp_ge_u32 s74, 76
    s_cselect_b32 s67, 0x1000000, 0
    s_lshl_b32 s68, s64, 2
    s_add_u32 s68, s68, s28
    s_lshl_b32 s68, s68, 10
    s_mul_i32 s69, s63, 156672
    s_add_u32 s68, s68, s69
    s_add_u32 s64, s64, 2
    s_lshr_b32 s62, s64, 3
    s_and_b32 s64, s64, 7
    s_xor_b32 s69, s63, s28
    s_lshr_b32 s70, s64, 1
    s_and_b32 s71, s64, 1
    s_lshl_b32 s65, s70, 7
    s_lshl_b32 s66, s71, 4
    s_add_u32 s65, s65, s66
    s_add_u32 s65, s65, s69
    s_lshl_b32 s69, s69, 2
    s_lshl_b32 s71, s71, 6
    s_add_u32 s69, s69, s71
    s_add_u32 s69, s69, s70
    s_add_u32 s70, s62, 1
    s_lshr_b32 s70, s70, 1
    s_lshl_b32 s70, s70, 2
    s_add_u32 s70, s70, s63
    s_lshl_b32 s70, s70, 9
    s_bitcmp1_b32 s62, 0
    s_cselect_b32 s65, s69, s65
    s_cselect_b32 s66, 10, 8
    s_add_u32 s65, s65, s70
    s_lshl_b32 s65, s65, 6
    s_bitcmp1_b32 s62, 0
    v_lshlrev_b32 v9, s66, v8
    v_lshl_add_u32 v9, v5, 4, v9
    v_add_u32 v9, s67, v9
    s_waitcnt lgkmcnt(0)
    s_cselect_b32 s16, s52, s50
    s_cselect_b32 s17, s53, s51
    s_add_u32 s8, s48, s3
    s_addc_u32 s9, s49, 0
    buffer_load_dwordx4 v[240:243], v9, s[16:19], s65 offen
    s_bitcmp1_b32 s62, 0
    s_mov_b32 s31, 1024
    s_cselect_b32 s31, 4096, s31
    s_add_u32 s65, s65, s31
    buffer_load_dwordx4 v[244:247], v9, s[16:19], s65 offen
    s_add_u32 m0, s32, 0
    s_mov_b32 s82, 0
    buffer_load_dwordx4 v16, s[8:11], s82 offen offset:0 nt lds
    s_mov_b64 s[12:13], s[52:53]
    s_add_u32 m0, s32, 20480
    s_add_u32 s30, s36, 0
    buffer_load_dwordx4 v18, s[12:15], s30 offen offset:0 lds
    global_load_dword a255, v4, s[52:53]
    s_add_u32 m0, s32, 0
    s_nop 0
    buffer_load_dwordx4 v17, s[8:11], s82 offen offset:1024 nt lds
    s_add_u32 m0, s32, 20480
    s_nop 0
    buffer_load_dwordx4 v19, s[12:15], s30 offen offset:1024 lds
    s_add_u32 m0, s32, 2048
    s_mov_b32 s82, 16384
    buffer_load_dwordx4 v16, s[8:11], s82 offen offset:0 nt lds
    s_add_u32 m0, s32, 20480
    s_add_u32 s30, s36, 2048
    buffer_load_dwordx4 v18, s[12:15], s30 offen offset:2048 lds
    s_add_u32 m0, s32, 2048
    s_nop 0
    buffer_load_dwordx4 v17, s[8:11], s82 offen offset:1024 nt lds
    s_add_u32 m0, s32, 20480
    s_nop 0
    buffer_load_dwordx4 v19, s[12:15], s30 offen offset:3072 lds
    s_xor_b32 s31, s28, 1
    s_mul_i32 s33, s31, 40960
    s_xor_b32 s37, s36, 256
    s_xor_b32 s31, s28, 2
    s_mul_i32 s34, s31, 40960
    s_xor_b32 s38, s36, 512
    s_xor_b32 s31, s28, 3
    s_mul_i32 s35, s31, 40960
    s_xor_b32 s39, s36, 768
    s_add_u32 s40, s56, s3
    s_addc_u32 s41, s57, 0
    s_add_u32 s42, s40, 16384
    s_addc_u32 s43, s41, 0
    s_add_u32 s44, s40, 32768
    s_addc_u32 s45, s41, 0
    s_add_u32 s46, s40, 49152
    s_addc_u32 s47, s41, 0
    s_mov_b32 s4, s58
    s_mov_b32 s5, s59
    s_mov_b32 s6, 256
    s_mov_b32 s7, 0x20000
    s_mov_b32 s20, s60
    s_mov_b32 s21, s61
    s_mov_b32 s22, 626688
    s_mov_b32 s23, 0x20000
    s_mul_i32 s3, s28, 115712
    s_add_u32 s3, s3, 4096
    s_add_u32 s24, s60, s3
    s_addc_u32 s25, s61, 0
    s_mov_b32 s29, 0xffff0000
    s_mov_b32 s81, 0
    v_lshrrev_b32 v4, 1, v7
    v_xor_b32 v4, v4, v5
    v_lshlrev_b32 v4, 4, v4
    v_lshl_add_u32 v4, v7, 7, v4
    v_xor_b32 v6, 64, v4
    v_lshlrev_b32 v3, 4, v1
    v_add_u32 v32, s32, v4
    v_add_u32 v33, s32, v6
    v_add_u32 v24, s32, v3
    v_add_u32 v34, s33, v4
    v_add_u32 v35, s33, v6
    v_add_u32 v25, s33, v3
    v_add_u32 v36, s34, v4
    v_add_u32 v37, s34, v6
    v_add_u32 v26, s34, v3
    v_add_u32 v38, s35, v4
    v_add_u32 v39, s35, v6
    v_add_u32 v27, s35, v3
    s_and_b32 s3, s28, 1
    s_lshl_b32 s3, s3, 6
    v_xor_b32 v28, s3, v28
    v_xor_b32 v31, 64, v28
    v_add_u32 v31, 3072, v31
    s_lshr_b32 s3, s28, 1
    s_lshl_b32 s3, s3, 7
    s_lshl_b32 s26, s28, 15
    s_add_u32 s26, s26, s3
    s_xor_b32 s27, s26, 128
    s_mov_b32 s83, 626688
    v_add_u32 v95, s67, v3
    v_lshlrev_b32 v29, 12, v0
    v_add_u32 v29, s67, v29
    v_and_b32 v4, 1, v5
    v_lshl_add_u32 v4, v4, 2, v8
    v_lshl_add_u32 v4, v2, 7, v4
    v_lshlrev_b32 v4, 1, v4
    global_load_ushort a24, v4, s[54:55] offset:0
    global_load_ushort a25, v4, s[54:55] offset:64
    global_load_ushort a26, v4, s[54:55] offset:128
    global_load_ushort a27, v4, s[54:55] offset:192
    global_load_ushort a28, v4, s[54:55] offset:1024
    global_load_ushort a29, v4, s[54:55] offset:1088
    global_load_ushort a30, v4, s[54:55] offset:1152
    global_load_ushort a31, v4, s[54:55] offset:1216
    global_load_ushort a32, v4, s[54:55] offset:2048
    global_load_ushort a33, v4, s[54:55] offset:2112
    global_load_ushort a34, v4, s[54:55] offset:2176
    global_load_ushort a35, v4, s[54:55] offset:2240
    v_mov_b32 v4, 0x3f80
    v_accvgpr_write_b32 a36, v4
    v_accvgpr_write_b32 a37, 0
    v_accvgpr_write_b32 a38, 0
    v_accvgpr_write_b32 a39, v4
    s_add_u32 m0, s32, 4096
    s_mov_b32 s82, 32768
    buffer_load_dwordx4 v16, s[8:11], s82 offen offset:0 nt lds
    s_waitcnt vmcnt(23)
    buffer_store_dwordx4 v[240:243], v95, s[20:23], s68 offen sc1
    s_add_u32 s68, s68, 4096
    s_waitcnt vmcnt(23)
    buffer_store_dwordx4 v[244:247], v95, s[20:23], s68 offen sc1
    s_mov_b64 vcc, -1
    s_cmp_eq_u32 s28, 0
    s_cbranch_scc1 L_LAND0_0
    s_cmp_eq_u32 s28, 1
    s_cbranch_scc1 L_LAND1_0
    s_cmp_eq_u32 s28, 2
    s_cbranch_scc1 L_LAND2_0
    s_branch L_LAND3_0
L_RET:
    s_mov_b64 vcc, 0
    s_add_u32 m0, s32, 24576
    s_add_u32 s30, s37, 0
    buffer_load_dwordx4 v18, s[12:15], s30 offen offset:0 lds
    s_add_u32 m0, s32, 4096
    s_nop 0
    buffer_load_dwordx4 v17, s[8:11], s82 offen offset:1024 nt lds
    s_waitcnt vmcnt(22)
    ds_read_b128 v[4:7], v32 offset:0
    ds_read_b128 v[12:15], v33 offset:0
    s_add_u32 m0, s32, 24576
    s_nop 0
    buffer_load_dwordx4 v19, s[12:15], s30 offen offset:1024 lds
    s_waitcnt lgkmcnt(1)
    v_lshlrev_b32 v0, 16, v4
    v_and_b32 v1, s29, v4
    v_lshlrev_b32 v2, 16, v5
    v_and_b32 v3, s29, v5
    v_lshlrev_b32 v4, 16, v6
    v_and_b32 v5, s29, v6
    v_lshlrev_b32 v6, 16, v7
    v_and_b32 v7, s29, v7
    ds_write_b128 v24, v[0:3] offset:28672
    ds_write_b128 v24, v[4:7] offset:29696
    s_add_u32 m0, s32, 6144
    s_mov_b32 s82, 49152
    buffer_load_dwordx4 v16, s[8:11], s82 offen offset:0 nt lds
    s_waitcnt lgkmcnt(2)
    v_lshlrev_b32 v8, 16, v12
    v_and_b32 v9, s29, v12
    v_lshlrev_b32 v10, 16, v13
    v_and_b32 v11, s29, v13
    v_lshlrev_b32 v12, 16, v14
    v_and_b32 v13, s29, v14
    v_lshlrev_b32 v14, 16, v15
    v_and_b32 v15, s29, v15
    ds_write_b128 v24, v[8:11] offset:34816
    ds_write_b128 v24, v[12:15] offset:35840
    s_add_u32 m0, s32, 24576
    s_add_u32 s30, s37, 2048
    buffer_load_dwordx4 v18, s[12:15], s30 offen offset:2048 lds
    s_add_u32 m0, s32, 6144
    s_nop 0
    buffer_load_dwordx4 v17, s[8:11], s82 offen offset:1024 nt lds
    s_waitcnt vmcnt(22)
    ds_read_b128 v[4:7], v32 offset:2048
    ds_read_b128 v[12:15], v33 offset:2048
    s_add_u32 m0, s32, 24576
    s_nop 0
    buffer_load_dwordx4 v19, s[12:15], s30 offen offset:3072 lds
    s_waitcnt lgkmcnt(1)
    v_lshlrev_b32 v0, 16, v4
    v_and_b32 v1, s29, v4
    v_lshlrev_b32 v2, 16, v5
    v_and_b32 v3, s29, v5
    v_lshlrev_b32 v4, 16, v6
    v_and_b32 v5, s29, v6
    v_lshlrev_b32 v6, 16, v7
    v_and_b32 v7, s29, v7
    ds_write_b128 v24, v[0:3] offset:30720
    ds_write_b128 v24, v[4:7] offset:31744
    s_add_u32 m0, s32, 8192
    s_mov_b32 s82, 128
    buffer_load_dwordx4 v16, s[8:11], s82 offen offset:0 nt lds
    s_waitcnt lgkmcnt(2)
    v_lshlrev_b32 v8, 16, v12
    v_and_b32 v9, s29, v12
    v_lshlrev_b32 v10, 16, v13
    v_and_b32 v11, s29, v13
    v_lshlrev_b32 v12, 16, v14
    v_and_b32 v13, s29, v14
    v_lshlrev_b32 v14, 16, v15
    v_and_b32 v15, s29, v15
    ds_write_b128 v24, v[8:11] offset:36864
    ds_write_b128 v24, v[12:15] offset:37888
    s_waitcnt vmcnt(8)
    s_barrier
    v_mov_b32 v30, 1
    buffer_atomic_add v30, v29, s[4:7], 0 offen sc0
    s_add_u32 m0, s32, 16384
    s_add_u32 s30, s38, 0
    buffer_load_dwordx4 v18, s[12:15], s30 offen offset:0 lds
    ds_read_b128 v[128:131], v32 offset:20480
    ds_read_b128 v[132:135], v33 offset:20480
    ds_read_b128 v[136:139], v32 offset:22528
    ds_read_b128 v[140:143], v33 offset:22528
    s_add_u32 m0, s32, 8192
    s_nop 0
    buffer_load_dwordx4 v17, s[8:11], s82 offen offset:1024 nt lds
    s_waitcnt vmcnt(9)
    ds_read_b128 v[4:7], v32 offset:4096
    ds_read_b128 v[12:15], v33 offset:4096
    s_add_u32 m0, s32, 16384
    s_nop 0
    buffer_load_dwordx4 v19, s[12:15], s30 offen offset:1024 lds
    s_waitcnt lgkmcnt(1)
    v_lshlrev_b32 v0, 16, v4
    v_and_b32 v1, s29, v4
    v_lshlrev_b32 v2, 16, v5
    v_and_b32 v3, s29, v5
    v_lshlrev_b32 v4, 16, v6
    v_and_b32 v5, s29, v6
    v_lshlrev_b32 v6, 16, v7
    v_and_b32 v7, s29, v7
    ds_write_b128 v24, v[0:3] offset:32768
    ds_write_b128 v24, v[4:7] offset:33792
    s_add_u32 m0, s32, 10240
    s_mov_b32 s82, 16512
    buffer_load_dwordx4 v16, s[8:11], s82 offen offset:0 nt lds
    s_waitcnt lgkmcnt(2)
    v_lshlrev_b32 v8, 16, v12
    v_and_b32 v9, s29, v12
    v_lshlrev_b32 v10, 16, v13
    v_and_b32 v11, s29, v13
    v_lshlrev_b32 v12, 16, v14
    v_and_b32 v13, s29, v14
    v_lshlrev_b32 v14, 16, v15
    v_and_b32 v15, s29, v15
    ds_write_b128 v24, v[8:11] offset:38912
    ds_write_b128 v24, v[12:15] offset:39936
    s_add_u32 m0, s32, 16384
    s_add_u32 s30, s38, 2048
    buffer_load_dwordx4 v18, s[12:15], s30 offen offset:2048 lds
    s_add_u32 m0, s32, 10240
    s_nop 0
    buffer_load_dwordx4 v17, s[8:11], s82 offen offset:1024 nt lds
    s_waitcnt vmcnt(9)
    ds_read_b128 v[4:7], v32 offset:6144
    ds_read_b128 v[12:15], v33 offset:6144
    s_add_u32 m0, s32, 16384
    s_nop 0
    buffer_load_dwordx4 v19, s[12:15], s30 offen offset:3072 lds
    s_waitcnt lgkmcnt(1)
    v_lshlrev_b32 v0, 16, v4
    v_and_b32 v1, s29, v4
    v_lshlrev_b32 v2, 16, v5
    v_and_b32 v3, s29, v5
    v_lshlrev_b32 v4, 16, v6
    v_and_b32 v5, s29, v6
    v_lshlrev_b32 v6, 16, v7
    v_and_b32 v7, s29, v7
    s_barrier
    ds_read_b128 a[40:43], v32 offset:0
    ds_read_b128 a[44:47], v33 offset:0
    ds_read_b128 a[48:51], v32 offset:2048
    ds_read_b128 a[52:55], v33 offset:2048
    ds_read_b128 a[56:59], v32 offset:4096
    ds_read_b128 a[60:63], v33 offset:4096
    ds_read_b128 a[64:67], v32 offset:6144
    s_waitcnt lgkmcnt(6)
    v_mfma_f32_16x16x32_bf16 v[96:99], v[128:131], a[40:43], 0
    s_add_u32 m0, s32, 12288
    s_mov_b32 s82, 32896
    buffer_load_dwordx4 v16, s[8:11], s82 offen offset:0 nt lds
    s_add_u32 m0, s32, 20480
    s_add_u32 s30, s39, 0
    s_waitcnt vmcnt(10)
    ds_read_b128 v[144:147], v32 offset:24576
    ds_read_b128 v[148:151], v33 offset:24576
    v_accvgpr_write_b32 a0, v0
    v_accvgpr_write_b32 a1, v1
    v_accvgpr_write_b32 a2, v2
    v_accvgpr_write_b32 a3, v3
    s_waitcnt lgkmcnt(7)
    v_mfma_f32_16x16x32_bf16 v[96:99], v[132:135], a[44:47], v[96:99]
    ds_read_b128 a[68:71], v33 offset:6144
    ds_read_b128 v[152:155], v32 offset:26624
    ds_read_b128 v[156:159], v33 offset:26624
    v_accvgpr_write_b32 a4, v4
    v_accvgpr_write_b32 a5, v5
    v_accvgpr_write_b32 a6, v6
    v_accvgpr_write_b32 a7, v7
    v_mfma_f32_16x16x32_bf16 v[100:103], v[136:139], a[40:43], 0
    v_lshlrev_b32 v8, 16, v12
    v_and_b32 v9, s29, v12
    v_lshlrev_b32 v10, 16, v13
    v_and_b32 v11, s29, v13
    v_mfma_f32_16x16x32_bf16 v[100:103], v[140:143], a[44:47], v[100:103]
    v_lshlrev_b32 v12, 16, v14
    v_and_b32 v13, s29, v14
    v_lshlrev_b32 v14, 16, v15
    v_and_b32 v15, s29, v15
    s_waitcnt lgkmcnt(9)
    v_mfma_f32_16x16x32_bf16 v[104:107], v[128:131], a[48:51], 0
    buffer_load_dwordx4 v18, s[12:15], s30 offen offset:0 lds
    ds_read_b128 a[72:75], v34 offset:0
    v_accvgpr_write_b32 a8, v8
    v_accvgpr_write_b32 a9, v9
    v_accvgpr_write_b32 a10, v10
    v_accvgpr_write_b32 a11, v11
    s_waitcnt lgkmcnt(9)
    v_mfma_f32_16x16x32_bf16 v[104:107], v[132:135], a[52:55], v[104:107]
    s_waitcnt vmcnt(9)
    v_xor_b32 v29, 75, v30
    v_lshlrev_b32 v29, 8, v29
    buffer_store_dword v30, v29, s[4:7], 0 offen offset:128 sc1
    ds_read_b128 a[76:79], v35 offset:0
    v_accvgpr_write_b32 a12, v12
    v_accvgpr_write_b32 a13, v13
    v_accvgpr_write_b32 a14, v14
    v_accvgpr_write_b32 a15, v15
    v_mfma_f32_16x16x32_bf16 v[108:111], v[136:139], a[48:51], 0
    v_mfma_f32_16x16x32_bf16 v[108:111], v[140:143], a[52:55], v[108:111]
    s_waitcnt lgkmcnt(9)
    v_mfma_f32_16x16x32_bf16 v[112:115], v[128:131], a[56:59], 0
    ds_read_b128 a[80:83], v34 offset:2048
    s_waitcnt lgkmcnt(9)
    v_mfma_f32_16x16x32_bf16 v[112:115], v[132:135], a[60:63], v[112:115]
    ds_read_b128 a[84:87], v35 offset:2048
    v_mfma_f32_16x16x32_bf16 v[116:119], v[136:139], a[56:59], 0
    v_mfma_f32_16x16x32_bf16 v[116:119], v[140:143], a[60:63], v[116:119]
    s_add_u32 m0, s32, 12288
    s_nop 0
    buffer_load_dwordx4 v17, s[8:11], s82 offen offset:1024 nt lds
    s_add_u32 m0, s32, 20480
    s_waitcnt lgkmcnt(9)
    v_mfma_f32_16x16x32_bf16 v[120:123], v[128:131], a[64:67], 0
    ds_read_b128 a[88:91], v34 offset:4096
    s_waitcnt lgkmcnt(7)
    v_mfma_f32_16x16x32_bf16 v[120:123], v[132:135], a[68:71], v[120:123]
    ds_read_b128 a[92:95], v35 offset:4096
    v_mfma_f32_16x16x32_bf16 v[124:127], v[136:139], a[64:67], 0
    v_mfma_f32_16x16x32_bf16 v[124:127], v[140:143], a[68:71], v[124:127]
    s_waitcnt lgkmcnt(5)
    v_mfma_f32_16x16x32_bf16 v[96:99], v[144:147], a[72:75], v[96:99]
    ds_read_b128 a[96:99], v34 offset:6144
    s_waitcnt lgkmcnt(5)
    v_mfma_f32_16x16x32_bf16 v[96:99], v[148:151], a[76:79], v[96:99]
    ds_read_b128 a[100:103], v35 offset:6144
    v_mfma_f32_16x16x4_4b_bf16 v[128:143], a[24:25], a[36:37], 1.0
    v_mfma_f32_16x16x32_bf16 v[100:103], v[152:155], a[72:75], v[100:103]
    v_mfma_f32_16x16x32_bf16 v[100:103], v[156:159], a[76:79], v[100:103]
    s_waitcnt lgkmcnt(5)
    v_mfma_f32_16x16x32_bf16 v[104:107], v[144:147], a[80:83], v[104:107]
    buffer_load_dwordx4 v19, s[12:15], s30 offen offset:1024 lds
    ds_read_b128 a[104:107], v36 offset:0
    s_waitcnt lgkmcnt(5)
    v_mfma_f32_16x16x32_bf16 v[104:107], v[148:151], a[84:87], v[104:107]
    ds_read_b128 a[108:111], v37 offset:0
    v_mfma_f32_16x16x32_bf16 v[108:111], v[152:155], a[80:83], v[108:111]
    v_mfma_f32_16x16x32_bf16 v[108:111], v[156:159], a[84:87], v[108:111]
    s_waitcnt lgkmcnt(5)
    v_mfma_f32_16x16x32_bf16 v[112:115], v[144:147], a[88:91], v[112:115]
    ds_read_b128 a[112:115], v36 offset:2048
    s_waitcnt lgkmcnt(5)
    v_mfma_f32_16x16x32_bf16 v[112:115], v[148:151], a[92:95], v[112:115]
    ds_read_b128 a[116:119], v37 offset:2048
    v_mfma_f32_16x16x32_bf16 v[116:119], v[152:155], a[88:91], v[116:119]
    v_mfma_f32_16x16x32_bf16 v[116:119], v[156:159], a[92:95], v[116:119]
    s_add_u32 m0, s32, 14336
    s_mov_b32 s82, 49280
    buffer_load_dwordx4 v16, s[8:11], s82 offen offset:0 nt lds
    s_add_u32 m0, s32, 20480
    s_add_u32 s30, s39, 2048
    buffer_load_dwordx4 v18, s[12:15], s30 offen offset:2048 lds
    s_add_u32 m0, s32, 14336
    s_nop 0
    buffer_load_dwordx4 v17, s[8:11], s82 offen offset:1024 nt lds
    s_add_u32 m0, s32, 20480
    s_nop 0
    buffer_load_dwordx4 v19, s[12:15], s30 offen offset:3072 lds
    s_add_u32 m0, s32, 24576
    s_add_u32 s30, s36, 128
    s_waitcnt vmcnt(9)
    ds_read_b128 v[160:163], v32 offset:16384
    ds_read_b128 v[164:167], v33 offset:16384
    ds_read_b128 v[168:171], v32 offset:18432
    ds_read_b128 v[172:175], v33 offset:18432
    s_waitcnt lgkmcnt(9)
    v_mfma_f32_16x16x32_bf16 v[120:123], v[144:147], a[96:99], v[120:123]
    ds_read_b128 a[120:123], v36 offset:4096
    s_waitcnt lgkmcnt(9)
    v_mfma_f32_16x16x32_bf16 v[120:123], v[148:151], a[100:103], v[120:123]
    ds_read_b128 a[124:127], v37 offset:4096
    v_mfma_f32_16x16x32_bf16 v[124:127], v[152:155], a[96:99], v[124:127]
    v_mfma_f32_16x16x32_bf16 v[124:127], v[156:159], a[100:103], v[124:127]
    s_waitcnt lgkmcnt(5)
    v_mfma_f32_16x16x32_bf16 v[96:99], v[160:163], a[104:107], v[96:99]
    ds_read_b128 a[128:131], v36 offset:6144
    s_waitcnt lgkmcnt(5)
    v_mfma_f32_16x16x32_bf16 v[96:99], v[164:167], a[108:111], v[96:99]
    ds_read_b128 a[132:135], v37 offset:6144
    v_mfma_f32_16x16x4_4b_bf16 v[144:159], a[24:25], a[36:37], 1.0
    s_waitcnt lgkmcnt(5)
    v_mfma_f32_16x16x32_bf16 v[100:103], v[168:171], a[104:107], v[100:103]
    buffer_load_dwordx4 v18, s[12:15], s30 offen offset:0 lds
    s_waitcnt lgkmcnt(4)
    v_mfma_f32_16x16x32_bf16 v[100:103], v[172:175], a[108:111], v[100:103]
    v_mfma_f32_16x16x32_bf16 v[104:107], v[160:163], a[112:115], v[104:107]
    ds_read_b128 a[136:139], v38 offset:0
    v_mfma_f32_16x16x32_bf16 v[104:107], v[164:167], a[116:119], v[104:107]
    ds_read_b128 a[140:143], v39 offset:0
    v_mfma_f32_16x16x32_bf16 v[108:111], v[168:171], a[112:115], v[108:111]
    v_mfma_f32_16x16x32_bf16 v[108:111], v[172:175], a[116:119], v[108:111]
    s_waitcnt lgkmcnt(5)
    v_mfma_f32_16x16x32_bf16 v[112:115], v[160:163], a[120:123], v[112:115]
    ds_read_b128 a[144:147], v38 offset:2048
    s_waitcnt lgkmcnt(5)
    v_mfma_f32_16x16x32_bf16 v[112:115], v[164:167], a[124:127], v[112:115]
    ds_read_b128 a[148:151], v39 offset:2048
    v_mfma_f32_16x16x32_bf16 v[116:119], v[168:171], a[120:123], v[116:119]
    v_mfma_f32_16x16x32_bf16 v[116:119], v[172:175], a[124:127], v[116:119]
    buffer_load_dwordx4 v19, s[12:15], s30 offen offset:1024 lds
    s_add_u32 s30, s36, 2176
    buffer_load_dwordx4 v18, s[12:15], s30 offen offset:2048 lds
    buffer_load_dwordx4 v19, s[12:15], s30 offen offset:3072 lds
    s_add_u32 m0, s32, 16384
L_LAND0_0:
    s_cbranch_vccnz L_RET
    s_add_u32 s30, s37, 128
    buffer_load_dwordx4 v18, s[12:15], s30 offen offset:0 lds
    buffer_load_dwordx4 v19, s[12:15], s30 offen offset:1024 lds
    s_add_u32 s30, s37, 2176
    buffer_load_dwordx4 v18, s[12:15], s30 offen offset:2048 lds
    buffer_load_dwordx4 v19, s[12:15], s30 offen offset:3072 lds
    s_add_u32 m0, s32, 20480
    s_add_u32 s30, s38, 128
    s_waitcnt vmcnt(8)
    ds_read_b128 v[176:179], v32 offset:20480
    ds_read_b128 v[180:183], v33 offset:20480
    ds_read_b128 v[184:187], v32 offset:22528
    ds_read_b128 v[188:191], v33 offset:22528
    s_waitcnt lgkmcnt(9)
    v_mfma_f32_16x16x32_bf16 v[120:123], v[160:163], a[128:131], v[120:123]
    ds_read_b128 a[152:155], v38 offset:4096
    s_waitcnt lgkmcnt(9)
    v_mfma_f32_16x16x32_bf16 v[120:123], v[164:167], a[132:135], v[120:123]
    s_waitcnt lgkmcnt(1)
    buffer_load_dwordx4 v18, s[12:15], s30 offen offset:0 lds
    ds_read_b128 a[156:159], v39 offset:4096
    v_mfma_f32_16x16x32_bf16 v[124:127], v[168:171], a[128:131], v[124:127]
    v_mfma_f32_16x16x32_bf16 v[124:127], v[172:175], a[132:135], v[124:127]
    v_mfma_f32_16x16x32_bf16 v[96:99], v[176:179], a[136:139], v[96:99]
    buffer_load_dwordx4 v19, s[12:15], s30 offen offset:1024 lds
    s_add_u32 s30, s38, 2176
    ds_read_b128 a[160:163], v38 offset:6144
    v_mfma_f32_16x16x32_bf16 v[96:99], v[180:183], a[140:143], v[96:99]
    ds_read_b128 a[164:167], v39 offset:6144
    v_mfma_f32_16x16x4_4b_bf16 v[160:175], a[24:25], a[38:39], 1.0
    v_mfma_f32_16x16x32_bf16 v[100:103], v[184:187], a[136:139], v[100:103]
    v_mfma_f32_16x16x32_bf16 v[100:103], v[188:191], a[140:143], v[100:103]
    buffer_load_dwordx4 v18, s[12:15], s30 offen offset:2048 lds
    v_mfma_f32_16x16x32_bf16 v[104:107], v[176:179], a[144:147], v[104:107]
    v_mfma_f32_16x16x32_bf16 v[104:107], v[180:183], a[148:151], v[104:107]
    v_mfma_f32_16x16x32_bf16 v[108:111], v[184:187], a[144:147], v[108:111]
    v_mfma_f32_16x16x32_bf16 v[108:111], v[188:191], a[148:151], v[108:111]
    buffer_load_dwordx4 v19, s[12:15], s30 offen offset:3072 lds
    s_add_u32 m0, s32, 24576
    s_add_u32 s30, s39, 128
    s_waitcnt vmcnt(8)
    ds_read_b128 v[192:195], v32 offset:24576
    ds_read_b128 v[196:199], v33 offset:24576
    s_waitcnt lgkmcnt(5)
    v_mfma_f32_16x16x32_bf16 v[112:115], v[176:179], a[152:155], v[112:115]
    ds_read_b128 v[200:203], v32 offset:26624
    ds_read_b128 v[204:207], v33 offset:26624
    s_waitcnt lgkmcnt(6)
    v_mfma_f32_16x16x32_bf16 v[112:115], v[180:183], a[156:159], v[112:115]
    v_mfma_f32_16x16x32_bf16 v[116:119], v[184:187], a[152:155], v[116:119]
    v_mfma_f32_16x16x32_bf16 v[116:119], v[188:191], a[156:159], v[116:119]
    s_waitcnt lgkmcnt(0)
    buffer_load_dwordx4 v18, s[12:15], s30 offen offset:0 lds
    v_mfma_f32_16x16x32_bf16 v[120:123], v[176:179], a[160:163], v[120:123]
    v_mfma_f32_16x16x32_bf16 v[120:123], v[180:183], a[164:167], v[120:123]
    v_mfma_f32_16x16x32_bf16 v[124:127], v[184:187], a[160:163], v[124:127]
    v_mfma_f32_16x16x32_bf16 v[124:127], v[188:191], a[164:167], v[124:127]
    s_nop 1
    v_mfma_f32_16x16x4_4b_bf16 v[176:191], a[24:25], a[38:39], 1.0
    s_barrier
    ds_read_b128 a[168:171], v32 offset:8192
    ds_read_b128 v[68:71], v33 offset:8192
    ds_read_b128 v[44:47], v32 offset:10240
    ds_read_b128 v[76:79], v33 offset:10240
    ds_read_b128 v[52:55], v32 offset:12288
    ds_read_b128 v[84:87], v33 offset:12288
    s_waitcnt lgkmcnt(5)
    v_mfma_f32_16x16x32_bf16 v[96:99], v[192:195], a[168:171], v[96:99]
    s_waitcnt lgkmcnt(4)
    buffer_load_dwordx4 v19, s[12:15], s30 offen offset:1024 lds
    v_mfma_f32_16x16x32_bf16 v[96:99], v[196:199], v[68:71], v[96:99]
    s_add_u32 s30, s39, 2176
    ds_read_b128 v[60:63], v32 offset:14336
    ds_read_b128 v[92:95], v33 offset:14336
    v_mfma_f32_16x16x32_bf16 v[100:103], v[200:203], a[168:171], v[100:103]
    ds_read_b128 v[4:7], v32 offset:8192
    v_mfma_f32_16x16x32_bf16 v[100:103], v[204:207], v[68:71], v[100:103]
    s_waitcnt lgkmcnt(6)
    ds_read_b128 a[172:175], v34 offset:8192
    v_mfma_f32_16x16x32_bf16 v[104:107], v[192:195], v[44:47], v[104:107]
    s_waitcnt lgkmcnt(6)
    buffer_load_dwordx4 v18, s[12:15], s30 offen offset:2048 lds
    v_mfma_f32_16x16x32_bf16 v[104:107], v[196:199], v[76:79], v[104:107]
    s_waitcnt vmcnt(7)
    ds_read_b128 v[208:211], v32 offset:16384
    ds_read_b128 v[212:215], v33 offset:16384
    v_mfma_f32_16x16x32_bf16 v[108:111], v[200:203], v[44:47], v[108:111]
    ds_read_b128 a[176:179], v35 offset:8192
    ds_read_b128 v[216:219], v32 offset:18432
    v_mfma_f32_16x16x32_bf16 v[108:111], v[204:207], v[76:79], v[108:111]
    s_waitcnt lgkmcnt(8)
    ds_read_b128 v[220:223], v33 offset:18432
    ds_read_b128 a[180:183], v34 offset:10240
    v_mfma_f32_16x16x32_bf16 v[112:115], v[192:195], v[52:55], v[112:115]
    buffer_load_dwordx4 v19, s[12:15], s30 offen offset:3072 lds
    v_mfma_f32_16x16x32_bf16 v[112:115], v[196:199], v[84:87], v[112:115]
    s_add_u32 m0, s32, 0
    s_sub_u32 s12, s50, 2048
    s_subb_u32 s13, s51, 0
    s_add_u32 s30, s26, 2048
    buffer_load_dword v30, off, s[4:7], 0 offset:128 sc1
    s_mov_b32 s80, 75
    v_mfma_f32_16x16x32_bf16 v[116:119], v[200:203], v[52:55], v[116:119]
    s_waitcnt lgkmcnt(6)
    ds_read_b128 a[184:187], v35 offset:10240
    v_lshlrev_b32 v0, 16, v4
    v_mfma_f32_16x16x32_bf16 v[116:119], v[204:207], v[84:87], v[116:119]
    buffer_load_dwordx4 v28, s[12:15], s30 offen offset:0 lds
    v_mfma_f32_16x16x32_bf16 v[120:123], v[192:195], v[60:63], v[120:123]
    ds_read_b128 a[188:191], v34 offset:12288
    v_and_b32 v1, s29, v4
    v_mfma_f32_16x16x32_bf16 v[120:123], v[196:199], v[92:95], v[120:123]
    ds_read_b128 a[192:195], v35 offset:12288
    v_lshlrev_b32 v2, 16, v5
    v_mfma_f32_16x16x32_bf16 v[124:127], v[200:203], v[60:63], v[124:127]
    v_and_b32 v3, s29, v5
    v_lshlrev_b32 v4, 16, v6
    v_mfma_f32_16x16x32_bf16 v[124:127], v[204:207], v[92:95], v[124:127]
    s_waitcnt lgkmcnt(3)
    buffer_load_dwordx4 v31, s[12:15], s30 offen offset:1024 lds
    v_mfma_f32_16x16x32_bf16 v[96:99], v[208:211], a[172:175], v[96:99]
    s_add_u32 s30, s27, 0
    ds_read_b128 a[196:199], v34 offset:14336
    v_and_b32 v5, s29, v6
    v_mfma_f32_16x16x32_bf16 v[96:99], v[212:215], a[176:179], v[96:99]
    ds_read_b128 a[200:203], v35 offset:14336
    v_lshlrev_b32 v6, 16, v7
    v_mfma_f32_16x16x32_bf16 v[100:103], v[216:219], a[172:175], v[100:103]
    v_and_b32 v7, s29, v7
    v_accvgpr_write_b32 a16, v0
    v_mfma_f32_16x16x32_bf16 v[100:103], v[220:223], a[176:179], v[100:103]
    v_accvgpr_write_b32 a17, v1
    v_accvgpr_write_b32 a18, v2
    v_mfma_f32_16x16x32_bf16 v[104:107], v[208:211], a[180:183], v[104:107]
    s_waitcnt vmcnt(9) lgkmcnt(2)
    buffer_load_dwordx4 v28, s[12:15], s30 offen offset:2048 lds
    v_mfma_f32_16x16x32_bf16 v[104:107], v[212:215], a[184:187], v[104:107]
    s_waitcnt vmcnt(8)
    ds_read_b128 v[224:227], v32 offset:20480
    ds_read_b128 a[204:207], v36 offset:8192
    v_mfma_f32_16x16x32_bf16 v[108:111], v[216:219], a[180:183], v[108:111]
    ds_read_b128 v[228:231], v33 offset:20480
    ds_read_b128 a[208:211], v37 offset:8192
    v_mfma_f32_16x16x32_bf16 v[108:111], v[220:223], a[184:187], v[108:111]
    s_waitcnt vmcnt(4) lgkmcnt(5)
    ds_read_b128 v[240:243], v32 offset:24576
    ds_read_b128 a[212:215], v38 offset:8192
    v_mfma_f32_16x16x32_bf16 v[112:115], v[208:211], a[188:191], v[112:115]
    buffer_load_dwordx4 v31, s[12:15], s30 offen offset:3072 lds
    v_mfma_f32_16x16x32_bf16 v[112:115], v[212:215], a[192:195], v[112:115]
    s_add_u32 m0, s32, 4096
    ds_read_b128 v[244:247], v33 offset:24576
    ds_read_b128 a[216:219], v39 offset:8192
    v_mfma_f32_16x16x32_bf16 v[116:119], v[216:219], a[188:191], v[116:119]
    s_add_u32 s30, s26, 3072
    ds_read_b128 v[232:235], v32 offset:22528
    ds_read_b128 v[236:239], v33 offset:22528
    v_mfma_f32_16x16x32_bf16 v[116:119], v[220:223], a[192:195], v[116:119]
    ds_read_b128 v[248:251], v32 offset:26624
    v_accvgpr_write_b32 a19, v3
    v_mfma_f32_16x16x32_bf16 v[120:123], v[208:211], a[196:199], v[120:123]
    s_waitcnt lgkmcnt(9)
    buffer_load_dwordx4 v28, s[12:15], s30 offen offset:0 lds
    v_mfma_f32_16x16x32_bf16 v[120:123], v[212:215], a[200:203], v[120:123]
    ds_read_b128 v[252:255], v33 offset:26624
    ds_read_b128 a[220:223], v36 offset:10240
    v_mfma_f32_16x16x32_bf16 v[124:127], v[216:219], a[196:199], v[124:127]
    ds_read_b128 a[224:227], v37 offset:10240
    v_accvgpr_write_b32 a20, v4
    v_mfma_f32_16x16x32_bf16 v[124:127], v[220:223], a[200:203], v[124:127]
    ds_read_b128 a[228:231], v38 offset:10240
    v_accvgpr_write_b32 a21, v5
    v_mfma_f32_16x16x32_bf16 v[96:99], v[224:227], a[204:207], v[96:99]
    s_waitcnt lgkmcnt(7)
    buffer_load_dwordx4 v31, s[12:15], s30 offen offset:1024 lds
    v_mfma_f32_16x16x32_bf16 v[96:99], v[228:231], a[208:211], v[96:99]
    s_add_u32 s30, s27, 1024
    ds_read_b128 a[232:235], v39 offset:10240
    v_accvgpr_write_b32 a22, v6
    v_mfma_f32_16x16x32_bf16 v[96:99], v[240:243], a[212:215], v[96:99]
    v_accvgpr_write_b32 a23, v7
    v_lshlrev_b32 v40, 16, v44
    v_mfma_f32_16x16x32_bf16 v[96:99], v[244:247], a[216:219], v[96:99]
    s_waitcnt lgkmcnt(5)
    v_and_b32 v41, s29, v44
    v_lshlrev_b32 v42, 16, v45
    v_mfma_f32_16x16x32_bf16 v[100:103], v[232:235], a[204:207], v[100:103]
    ds_read_b128 a[236:239], v36 offset:12288
    v_and_b32 v43, s29, v45
    v_mfma_f32_16x16x32_bf16 v[100:103], v[236:239], a[208:211], v[100:103]
    buffer_load_dwordx4 v28, s[12:15], s30 offen offset:2048 lds
    v_mfma_f32_16x16x32_bf16 v[100:103], v[248:251], a[212:215], v[100:103]
    s_waitcnt lgkmcnt(2)
    ds_read_b128 a[240:243], v37 offset:12288
    v_cvt_pk_bf16_f32 v96, v96, v97
    v_mfma_f32_16x16x32_bf16 v[100:103], v[252:255], a[216:219], v[100:103]
    ds_read_b128 a[244:247], v38 offset:12288
    v_cvt_pk_bf16_f32 v97, v98, v99
    v_mfma_f32_16x16x32_bf16 v[104:107], v[224:227], a[220:223], v[104:107]
    ds_read_b128 a[248:251], v39 offset:12288
    v_lshlrev_b32 v44, 16, v46
    v_mfma_f32_16x16x32_bf16 v[104:107], v[228:231], a[224:227], v[104:107]
    buffer_load_dwordx4 v31, s[12:15], s30 offen offset:3072 lds
    v_mfma_f32_16x16x32_bf16 v[104:107], v[240:243], a[228:231], v[104:107]
    s_waitcnt lgkmcnt(4)
    s_waitcnt vmcnt(8)
    v_cmp_ne_u32 vcc, s80, v30
    s_nop 1
    s_cbranch_vccnz L_SLOWB
L_FASTB:
    s_mov_b32 s22, s83
    s_lshr_b32 s3, s2, 3
    s_mul_i32 s3, s3, 4864
    s_mul_i32 s31, s28, 156672
    s_add_u32 s3, s3, s31
    v_subrev_u32 v29, s32, v24
    v_lshlrev_b32 v29, 3, v29
    v_min_u32 v29, 4736, v29
    buffer_load_dword a253, v29, s[20:23], s3 offen sc1
    v_mfma_f32_16x16x32_bf16 v[104:107], v[244:247], a[232:235], v[104:107]
    global_load_dwordx4 a[40:43], v24, s[24:25] offset:-4096 sc1
    v_cvt_pk_bf16_f32 v98, v100, v101
    v_mfma_f32_16x16x32_bf16 v[108:111], v[232:235], a[220:223], v[108:111]
    ds_read_b128 a[44:47], v36 offset:14336
    v_cvt_pk_bf16_f32 v99, v102, v103
    v_mfma_f32_16x16x32_bf16 v[108:111], v[236:239], a[224:227], v[108:111]
    ds_read_b128 a[48:51], v37 offset:14336
    v_and_b32 v45, s29, v46
    v_mfma_f32_16x16x4_4b_bf16 v[192:207], a[26:27], a[36:37], 1.0
    ds_write_b128 v24, v[96:99] offset:16384
    v_cvt_pk_bf16_f32 v104, v104, v105
    v_cvt_pk_bf16_f32 v105, v106, v107
    v_lshlrev_b32 v46, 16, v47
    v_mfma_f32_16x16x32_bf16 v[108:111], v[248:251], a[228:231], v[108:111]
    global_load_dwordx4 a[52:55], v24, s[24:25] offset:-3072 sc1
    v_and_b32 v47, s29, v47
    v_mfma_f32_16x16x32_bf16 v[108:111], v[252:255], a[232:235], v[108:111]
    s_waitcnt vmcnt(10) lgkmcnt(3)
    ds_read_b128 a[56:59], v38 offset:14336
    v_lshlrev_b32 v48, 16, v52
    v_mfma_f32_16x16x32_bf16 v[112:115], v[224:227], a[236:239], v[112:115]
    ds_read_b128 a[60:63], v39 offset:14336
    global_load_dwordx4 a[64:67], v24, s[24:25] offset:-2048 sc1
    v_mfma_f32_16x16x32_bf16 v[112:115], v[228:231], a[240:243], v[112:115]
    ds_read_b128 v[16:19], v24 offset:28672
    v_cvt_pk_bf16_f32 v106, v108, v109
    v_mfma_f32_16x16x32_bf16 v[112:115], v[240:243], a[244:247], v[112:115]
    ds_read_b128 v[20:23], v24 offset:29696
    v_cvt_pk_bf16_f32 v107, v110, v111
    v_mfma_f32_16x16x32_bf16 v[112:115], v[244:247], a[248:251], v[112:115]
    v_and_b32 v49, s29, v52
    v_lshlrev_b32 v50, 16, v53
    v_mfma_f32_16x16x4_4b_bf16 v[208:223], a[26:27], a[36:37], 1.0
    ds_write_b128 v24, v[104:107] offset:17408
    v_and_b32 v51, s29, v53
    v_lshlrev_b32 v52, 16, v54
    v_and_b32 v53, s29, v54
    v_mfma_f32_16x16x32_bf16 v[116:119], v[232:235], a[236:239], v[116:119]
    global_load_dwordx4 a[68:71], v24, s[24:25] offset:-1024 sc1
    v_cvt_pk_bf16_f32 v112, v112, v113
    v_mfma_f32_16x16x32_bf16 v[116:119], v[236:239], a[240:243], v[116:119]
    s_waitcnt vmcnt(9) lgkmcnt(5)
    ds_read_b128 a[72:75], v32 offset:0
    v_cvt_pk_bf16_f32 v113, v114, v115
    v_mfma_f32_16x16x32_bf16 v[116:119], v[248:251], a[244:247], v[116:119]
    s_waitcnt lgkmcnt(1)
    s_barrier
    v_mfma_f32_16x16x32_bf16 v[116:119], v[252:255], a[248:251], v[116:119]
    ds_read_b128 a[76:79], v33 offset:0
    global_load_dwordx4 a[80:83], v24, s[24:25] offset:0 sc1
    v_mfma_f32_16x16x32_bf16 v[120:123], v[224:227], a[44:47], v[120:123]
    ds_read_b128 v[100:103], v25 offset:16384
    ds_read_b128 a[84:87], v32 offset:2048
    v_mfma_f32_16x16x32_bf16 v[120:123], v[228:231], a[48:51], v[120:123]
    ds_read_b128 a[88:91], v26 offset:16384
    ds_read_b128 a[92:95], v33 offset:2048
    v_mfma_f32_16x16x32_bf16 v[120:123], v[240:243], a[56:59], v[120:123]
    ds_read_b128 a[96:99], v27 offset:16384
    global_load_dwordx4 a[100:103], v24, s[24:25] offset:1024 sc1
    v_mfma_f32_16x16x32_bf16 v[120:123], v[244:247], a[60:63], v[120:123]
    s_waitcnt vmcnt(7)
    ds_read_b128 a[104:107], v32 offset:4096
    ds_read_b128 a[108:111], v33 offset:4096
    v_mfma_f32_16x16x32_bf16 v[124:127], v[232:235], a[44:47], v[124:127]
    ds_read_b128 a[112:115], v32 offset:6144
    v_cvt_pk_bf16_f32 v114, v116, v117
    v_mfma_f32_16x16x32_bf16 v[124:127], v[236:239], a[48:51], v[124:127]
    ds_read_b128 a[116:119], v33 offset:6144
    v_cvt_pk_bf16_f32 v115, v118, v119
    v_mfma_f32_16x16x32_bf16 v[124:127], v[248:251], a[56:59], v[124:127]
    ds_read_b128 v[8:11], v24 offset:30720
    v_cvt_pk_bf16_f32 v120, v120, v121
    v_mfma_f32_16x16x4_4b_bf16 v[224:239], a[26:27], a[38:39], 1.0
    ds_write_b128 v24, v[112:115] offset:18432
    v_cvt_pk_bf16_f32 v121, v122, v123
    v_lshlrev_b32 v54, 16, v55
    v_and_b32 v55, s29, v55
    v_mfma_f32_16x16x32_bf16 v[124:127], v[252:255], a[60:63], v[124:127]
    s_waitcnt lgkmcnt(9)
    global_load_dwordx4 a[120:123], v24, s[24:25] offset:2048 sc1
    v_lshlrev_b32 v56, 16, v60
    v_mfma_f32_16x16x32_bf16 v[128:131], a[72:75], v[96:99], v[128:131]
    ds_read_b128 v[108:111], v25 offset:17408
    global_load_dwordx4 a[124:127], v24, s[24:25] offset:3072 sc1
    v_mfma_f32_16x16x32_bf16 v[128:131], a[76:79], v[100:103], v[128:131]
    s_waitcnt lgkmcnt(7)
    ds_read_b128 a[128:131], v26 offset:17408
    s_add_u32 s24, s24, 8192
    v_mfma_f32_16x16x32_bf16 v[128:131], a[84:87], a[88:91], v[128:131]
    s_addc_u32 s25, s25, 0
    ds_read_b128 a[132:135], v27 offset:17408
    v_cvt_pk_bf16_f32 v122, v124, v125
    v_mfma_f32_16x16x32_bf16 v[128:131], a[92:95], a[96:99], v[128:131]
    s_waitcnt lgkmcnt(6)
    ds_read_b128 v[12:15], v24 offset:31744
    v_cvt_pk_bf16_f32 v123, v126, v127
    v_mfma_f32_16x16x32_bf16 v[132:135], a[104:107], v[96:99], v[132:135]
    ds_read_b128 v[0:3], v24 offset:32768
    v_and_b32 v57, s29, v60
    v_mfma_f32_16x16x4_4b_bf16 v[240:255], a[26:27], a[38:39], 1.0
    ds_write_b128 v24, v[120:123] offset:19456
    v_lshlrev_b32 v58, 16, v61
    v_and_b32 v59, s29, v61
    v_lshlrev_b32 v60, 16, v62
    v_mfma_f32_16x16x32_bf16 v[132:135], a[108:111], v[100:103], v[132:135]
    global_load_dwordx4 a[136:139], v24, s[24:25] offset:-4096 sc1
    v_and_b32 v61, s29, v62
    v_mfma_f32_16x16x32_bf16 v[132:135], a[112:115], a[88:91], v[132:135]
    s_waitcnt lgkmcnt(6)
    s_barrier
    v_mfma_f32_16x16x32_bf16 v[132:135], a[116:119], a[96:99], v[132:135]
    ds_read_b128 v[116:119], v25 offset:18432
    global_load_dwordx4 a[140:143], v24, s[24:25] offset:-3072 sc1
    v_mfma_f32_16x16x32_bf16 v[136:139], a[72:75], v[104:107], v[136:139]
    s_waitcnt lgkmcnt(5)
    ds_read_b128 a[144:147], v26 offset:18432
    v_lshlrev_b32 v62, 16, v63
    v_mfma_f32_16x16x32_bf16 v[136:139], a[76:79], v[108:111], v[136:139]
    ds_read_b128 a[148:151], v27 offset:18432
    v_and_b32 v63, s29, v63
    v_mfma_f32_16x16x32_bf16 v[136:139], a[84:87], a[128:131], v[136:139]
    s_waitcnt lgkmcnt(5)
    ds_read_b128 v[4:7], v24 offset:33792
    v_lshlrev_b32 v64, 16, v68
    v_mfma_f32_16x16x32_bf16 v[136:139], a[92:95], a[132:135], v[136:139]
    global_load_dwordx4 a[152:155], v24, s[24:25] offset:-2048 sc1
    v_and_b32 v65, s29, v68
    v_mfma_f32_16x16x32_bf16 v[140:143], a[104:107], v[104:107], v[140:143]
    v_lshlrev_b32 v66, 16, v69
    v_and_b32 v67, s29, v69
    v_mfma_f32_16x16x32_bf16 v[140:143], a[108:111], v[108:111], v[140:143]
    v_lshlrev_b32 v68, 16, v70
    v_and_b32 v69, s29, v70
    v_mfma_f32_16x16x32_bf16 v[140:143], a[112:115], a[128:131], v[140:143]
    s_waitcnt vmcnt(11) lgkmcnt(3)
    s_barrier
    v_mfma_f32_16x16x32_bf16 v[140:143], a[116:119], a[132:135], v[140:143]
    ds_read_b128 v[124:127], v25 offset:19456
    global_load_dwordx4 a[156:159], v24, s[24:25] offset:-1024 sc1
    v_mfma_f32_16x16x32_bf16 v[144:147], a[72:75], v[112:115], v[144:147]
    ds_read_b128 a[160:163], v26 offset:19456
    v_lshlrev_b32 v70, 16, v71
    v_mfma_f32_16x16x32_bf16 v[144:147], a[76:79], v[116:119], v[144:147]
    s_waitcnt vmcnt(11) lgkmcnt(2)
    ds_read_b128 a[164:167], v27 offset:19456
    v_and_b32 v71, s29, v71
    v_mfma_f32_16x16x32_bf16 v[144:147], a[84:87], a[144:147], v[144:147]
    v_lshlrev_b32 v72, 16, v76
    v_and_b32 v73, s29, v76
    v_mfma_f32_16x16x32_bf16 v[144:147], a[92:95], a[148:151], v[144:147]
    global_load_dwordx4 a[168:171], v24, s[24:25] offset:0 sc1
    v_lshlrev_b32 v74, 16, v77
    v_mfma_f32_16x16x32_bf16 v[148:151], a[104:107], v[112:115], v[148:151]
    v_and_b32 v75, s29, v77
    v_lshlrev_b32 v76, 16, v78
    v_mfma_f32_16x16x32_bf16 v[148:151], a[108:111], v[116:119], v[148:151]
    v_and_b32 v77, s29, v78
    v_lshlrev_b32 v78, 16, v79
    v_mfma_f32_16x16x32_bf16 v[148:151], a[112:115], a[144:147], v[148:151]
    v_and_b32 v79, s29, v79
    v_lshlrev_b32 v80, 16, v84
    v_mfma_f32_16x16x32_bf16 v[148:151], a[116:119], a[148:151], v[148:151]
    global_load_dwordx4 a[172:175], v24, s[24:25] offset:1024 sc1
    v_and_b32 v81, s29, v84
    v_mfma_f32_16x16x32_bf16 v[152:155], a[72:75], v[120:123], v[152:155]
    s_waitcnt vmcnt(10) lgkmcnt(0)
    v_lshlrev_b32 v82, 16, v85
    v_and_b32 v83, s29, v85
    v_mfma_f32_16x16x32_bf16 v[152:155], a[76:79], v[124:127], v[152:155]
    v_lshlrev_b32 v84, 16, v86
    v_and_b32 v85, s29, v86
    v_mfma_f32_16x16x32_bf16 v[152:155], a[84:87], a[160:163], v[152:155]
    v_lshlrev_b32 v86, 16, v87
    v_and_b32 v87, s29, v87
    v_mfma_f32_16x16x32_bf16 v[152:155], a[92:95], a[164:167], v[152:155]
    v_lshlrev_b32 v88, 16, v92
    v_and_b32 v89, s29, v92
    v_mfma_f32_16x16x32_bf16 v[156:159], a[104:107], v[120:123], v[156:159]
    global_load_dwordx4 a[176:179], v24, s[24:25] offset:2048 sc1
    v_lshlrev_b32 v90, 16, v93
    v_mfma_f32_16x16x32_bf16 v[156:159], a[108:111], v[124:127], v[156:159]
    v_and_b32 v91, s29, v93
    v_lshlrev_b32 v92, 16, v94
    v_mfma_f32_16x16x32_bf16 v[156:159], a[112:115], a[160:163], v[156:159]
    v_and_b32 v93, s29, v94
    v_lshlrev_b32 v94, 16, v95
    v_mfma_f32_16x16x32_bf16 v[156:159], a[116:119], a[164:167], v[156:159]
    v_and_b32 v95, s29, v95
    v_mul_f32 v16, v16, v128
    v_mfma_f32_16x16x32_bf16 v[160:163], a[40:43], v[96:99], v[160:163]
    global_load_dwordx4 a[180:183], v24, s[24:25] offset:3072 sc1
    v_mul_f32 v17, v17, v129
    v_mfma_f32_16x16x32_bf16 v[160:163], a[52:55], v[100:103], v[160:163]
    s_add_u32 s24, s24, 8192
    v_mul_f32 v18, v18, v130
    v_mul_f32 v19, v19, v131
    v_mfma_f32_16x16x32_bf16 v[160:163], a[64:67], a[88:91], v[160:163]
    s_addc_u32 s25, s25, 0
    v_cvt_pk_bf16_f32 v16, v16, v17
    v_cvt_pk_bf16_f32 v17, v18, v19
    v_mfma_f32_16x16x32_bf16 v[160:163], a[68:71], a[96:99], v[160:163]
    s_waitcnt vmcnt(9)
    v_mul_f32 v20, v20, v132
    v_mul_f32 v21, v21, v133
    v_mfma_f32_16x16x32_bf16 v[164:167], a[80:83], v[96:99], v[164:167]
    global_load_dwordx4 a[184:187], v24, s[24:25] offset:-4096 sc1
    v_mul_f32 v22, v22, v134
    v_mfma_f32_16x16x32_bf16 v[164:167], a[100:103], v[100:103], v[164:167]
    v_mul_f32 v23, v23, v135
    v_cvt_pk_bf16_f32 v18, v20, v21
    v_mfma_f32_16x16x32_bf16 v[164:167], a[120:123], a[88:91], v[164:167]
    s_waitcnt vmcnt(9)
    v_cvt_pk_bf16_f32 v19, v22, v23
    v_mul_f32 v8, v8, v136
    v_mfma_f32_16x16x32_bf16 v[164:167], a[124:127], a[96:99], v[164:167]
    ds_write_b128 v24, v[16:19] offset:0
    v_mfma_f32_16x16x32_bf16 v[168:171], a[40:43], v[104:107], v[168:171]
    global_load_dwordx4 a[188:191], v24, s[24:25] offset:-3072 sc1
    v_mul_f32 v9, v9, v137
    v_mfma_f32_16x16x32_bf16 v[168:171], a[52:55], v[108:111], v[168:171]
    v_mul_f32 v10, v10, v138
    v_mul_f32 v11, v11, v139
    v_mfma_f32_16x16x32_bf16 v[168:171], a[64:67], a[128:131], v[168:171]
    v_cvt_pk_bf16_f32 v8, v8, v9
    v_cvt_pk_bf16_f32 v9, v10, v11
    v_mfma_f32_16x16x32_bf16 v[168:171], a[68:71], a[132:135], v[168:171]
    v_mul_f32 v12, v12, v140
    v_mul_f32 v13, v13, v141
    v_mfma_f32_16x16x32_bf16 v[172:175], a[80:83], v[104:107], v[172:175]
    global_load_dwordx4 a[192:195], v24, s[24:25] offset:-2048 sc1
    v_mul_f32 v14, v14, v142
    v_mfma_f32_16x16x32_bf16 v[172:175], a[100:103], v[108:111], v[172:175]
    v_mul_f32 v15, v15, v143
    v_cvt_pk_bf16_f32 v10, v12, v13
    v_mfma_f32_16x16x32_bf16 v[172:175], a[120:123], a[128:131], v[172:175]
    v_cvt_pk_bf16_f32 v11, v14, v15
    v_mul_f32 v0, v0, v144
    v_mfma_f32_16x16x32_bf16 v[172:175], a[124:127], a[132:135], v[172:175]
    v_mul_f32 v1, v1, v145
    v_mul_f32 v2, v2, v146
    v_mfma_f32_16x16x4_4b_bf16 v[128:143], a[28:29], a[36:37], v[128:143]
    ds_write_b128 v24, v[8:11] offset:2048
    v_mul_f32 v3, v3, v147
    v_cvt_pk_bf16_f32 v0, v0, v1
    v_cvt_pk_bf16_f32 v1, v2, v3
    v_mfma_f32_16x16x32_bf16 v[176:179], a[40:43], v[112:115], v[176:179]
    global_load_dwordx4 a[196:199], v24, s[24:25] offset:-1024 sc1
    v_mul_f32 v4, v4, v148
    v_mfma_f32_16x16x32_bf16 v[176:179], a[52:55], v[116:119], v[176:179]
    ds_read_b128 v[8:11], v24 offset:34816
    v_mul_f32 v5, v5, v149
    v_mfma_f32_16x16x32_bf16 v[176:179], a[64:67], a[144:147], v[176:179]
    ds_read_b128 v[12:15], v24 offset:35840
    global_load_dwordx4 a[200:203], v24, s[24:25] offset:0 sc1
    v_mfma_f32_16x16x32_bf16 v[176:179], a[68:71], a[148:151], v[176:179]
    v_mul_f32 v6, v6, v150
    v_mul_f32 v7, v7, v151
    v_mfma_f32_16x16x32_bf16 v[180:183], a[80:83], v[112:115], v[180:183]
    v_cvt_pk_bf16_f32 v2, v4, v5
    v_cvt_pk_bf16_f32 v3, v6, v7
    v_mfma_f32_16x16x32_bf16 v[180:183], a[100:103], v[116:119], v[180:183]
    ds_write_b128 v24, v[0:3] offset:4096
    v_mfma_f32_16x16x32_bf16 v[180:183], a[120:123], a[144:147], v[180:183]
    global_load_dwordx4 a[204:207], v24, s[24:25] offset:1024 sc1
    v_accvgpr_read_b32 v16, a0
    v_mfma_f32_16x16x32_bf16 v[180:183], a[124:127], a[148:151], v[180:183]
    v_accvgpr_read_b32 v17, a1
    v_accvgpr_read_b32 v18, a2
    v_mfma_f32_16x16x32_bf16 v[184:187], a[40:43], v[120:123], v[184:187]
    ds_read_b128 v[0:3], v24 offset:36864
    v_accvgpr_read_b32 v19, a3
    v_mfma_f32_16x16x32_bf16 v[184:187], a[52:55], v[124:127], v[184:187]
    ds_read_b128 v[4:7], v24 offset:37888
    v_accvgpr_read_b32 v20, a4
    v_mfma_f32_16x16x32_bf16 v[184:187], a[64:67], a[160:163], v[184:187]
    global_load_dwordx4 a[208:211], v24, s[24:25] offset:2048 sc1
    v_accvgpr_read_b32 v21, a5
    v_mfma_f32_16x16x32_bf16 v[184:187], a[68:71], a[164:167], v[184:187]
    v_accvgpr_read_b32 v22, a6
    v_accvgpr_read_b32 v23, a7
    v_mfma_f32_16x16x32_bf16 v[188:191], a[80:83], v[120:123], v[188:191]
    v_mul_f32 v16, v16, v152
    v_mul_f32 v17, v17, v153
    v_mfma_f32_16x16x32_bf16 v[188:191], a[100:103], v[124:127], v[188:191]
    v_mul_f32 v18, v18, v154
    v_mul_f32 v19, v19, v155
    v_mfma_f32_16x16x32_bf16 v[188:191], a[120:123], a[160:163], v[188:191]
    global_load_dwordx4 a[212:215], v24, s[24:25] offset:3072 sc1
    v_cvt_pk_bf16_f32 v16, v16, v17
    v_mfma_f32_16x16x32_bf16 v[188:191], a[124:127], a[164:167], v[188:191]
    s_waitcnt vmcnt(10) lgkmcnt(1)
    s_add_u32 s24, s24, 8192
    v_cvt_pk_bf16_f32 v17, v18, v19
    v_mfma_f32_16x16x32_bf16 v[192:195], a[136:139], v[96:99], v[192:195]
    s_addc_u32 s25, s25, 0
    v_mul_f32 v20, v20, v156
    v_mul_f32 v21, v21, v157
    v_mfma_f32_16x16x32_bf16 v[192:195], a[140:143], v[100:103], v[192:195]
    v_mul_f32 v22, v22, v158
    v_mul_f32 v23, v23, v159
    v_mfma_f32_16x16x32_bf16 v[192:195], a[152:155], a[88:91], v[192:195]
    global_load_dwordx4 a[216:219], v24, s[24:25] offset:-4096 sc1
    v_cvt_pk_bf16_f32 v18, v20, v21
    v_mfma_f32_16x16x32_bf16 v[192:195], a[156:159], a[96:99], v[192:195]
    v_cvt_pk_bf16_f32 v19, v22, v23
    v_mul_f32 v8, v8, v160
    v_mfma_f32_16x16x32_bf16 v[196:199], a[168:171], v[96:99], v[196:199]
    v_mul_f32 v9, v9, v161
    v_mul_f32 v10, v10, v162
    v_mfma_f32_16x16x4_4b_bf16 v[144:159], a[28:29], a[36:37], v[144:159]
    ds_write_b128 v24, v[16:19] offset:6144
    v_mul_f32 v11, v11, v163
    v_cvt_pk_bf16_f32 v8, v8, v9
    v_cvt_pk_bf16_f32 v9, v10, v11
    v_mfma_f32_16x16x32_bf16 v[196:199], a[172:175], v[100:103], v[196:199]
    s_waitcnt vmcnt(9) lgkmcnt(1)
    global_load_dwordx4 a[220:223], v24, s[24:25] offset:-3072 sc1
    v_mul_f32 v12, v12, v164
    v_mfma_f32_16x16x32_bf16 v[196:199], a[176:179], a[88:91], v[196:199]
    ds_read_b128 v[16:19], v24 offset:38912
    v_mul_f32 v13, v13, v165
    v_mfma_f32_16x16x32_bf16 v[196:199], a[180:183], a[96:99], v[196:199]
    ds_read_b128 v[20:23], v24 offset:39936
    v_mul_f32 v14, v14, v166
    v_mfma_f32_16x16x32_bf16 v[200:203], a[136:139], v[104:107], v[200:203]
    global_load_dwordx4 a[224:227], v24, s[24:25] offset:-2048 sc1
    v_mul_f32 v15, v15, v167
    v_mfma_f32_16x16x32_bf16 v[200:203], a[140:143], v[108:111], v[200:203]
    v_cvt_pk_bf16_f32 v10, v12, v13
    v_cvt_pk_bf16_f32 v11, v14, v15
    v_mfma_f32_16x16x32_bf16 v[200:203], a[152:155], a[128:131], v[200:203]
    ds_write_b128 v24, v[8:11] offset:1024
    v_mfma_f32_16x16x32_bf16 v[200:203], a[156:159], a[132:135], v[200:203]
    v_mul_f32 v0, v0, v168
    v_mul_f32 v1, v1, v169
    v_mfma_f32_16x16x32_bf16 v[204:207], a[168:171], v[104:107], v[204:207]
    global_load_dwordx4 a[228:231], v24, s[24:25] offset:-1024 sc1
    v_mul_f32 v2, v2, v170
    v_mfma_f32_16x16x32_bf16 v[204:207], a[172:175], v[108:111], v[204:207]
    v_mul_f32 v3, v3, v171
    v_cvt_pk_bf16_f32 v0, v0, v1
    v_mfma_f32_16x16x32_bf16 v[204:207], a[176:179], a[128:131], v[204:207]
    v_cvt_pk_bf16_f32 v1, v2, v3
    v_mul_f32 v4, v4, v172
    v_mfma_f32_16x16x32_bf16 v[204:207], a[180:183], a[132:135], v[204:207]
    v_mul_f32 v5, v5, v173
    v_mul_f32 v6, v6, v174
    v_mfma_f32_16x16x32_bf16 v[208:211], a[136:139], v[112:115], v[208:211]
    global_load_dwordx4 a[232:235], v24, s[24:25] offset:0 sc1
    v_mul_f32 v7, v7, v175
    v_mfma_f32_16x16x32_bf16 v[208:211], a[140:143], v[116:119], v[208:211]
    v_cvt_pk_bf16_f32 v2, v4, v5
    v_cvt_pk_bf16_f32 v3, v6, v7
    v_mfma_f32_16x16x32_bf16 v[208:211], a[152:155], a[144:147], v[208:211]
    s_waitcnt vmcnt(10) lgkmcnt(0)
    v_mul_f32 v16, v16, v176
    v_mul_f32 v17, v17, v177
    v_mfma_f32_16x16x4_4b_bf16 v[160:175], a[28:29], a[38:39], v[160:175]
    ds_write_b128 v24, v[0:3] offset:3072
    v_mul_f32 v18, v18, v178
    v_mul_f32 v19, v19, v179
    v_cvt_pk_bf16_f32 v16, v16, v17
    v_mfma_f32_16x16x32_bf16 v[208:211], a[156:159], a[148:151], v[208:211]
    global_load_dwordx4 a[236:239], v24, s[24:25] offset:1024 sc1
    v_cvt_pk_bf16_f32 v17, v18, v19
    v_mfma_f32_16x16x32_bf16 v[212:215], a[168:171], v[112:115], v[212:215]
    v_mul_f32 v20, v20, v180
    v_mul_f32 v21, v21, v181
    v_mfma_f32_16x16x32_bf16 v[212:215], a[172:175], v[116:119], v[212:215]
    v_mul_f32 v22, v22, v182
    v_mul_f32 v23, v23, v183
    v_mfma_f32_16x16x32_bf16 v[212:215], a[176:179], a[144:147], v[212:215]
    global_load_dwordx4 a[240:243], v24, s[24:25] offset:2048 sc1
    v_cvt_pk_bf16_f32 v18, v20, v21
    v_mfma_f32_16x16x32_bf16 v[212:215], a[180:183], a[148:151], v[212:215]
    v_cvt_pk_bf16_f32 v19, v22, v23
    v_accvgpr_read_b32 v8, a8
    v_mfma_f32_16x16x32_bf16 v[216:219], a[136:139], v[120:123], v[216:219]
    ds_write_b128 v24, v[16:19] offset:5120
    v_mfma_f32_16x16x32_bf16 v[216:219], a[140:143], v[124:127], v[216:219]
    global_load_dwordx4 a[244:247], v24, s[24:25] offset:3072 sc1
    v_accvgpr_read_b32 v9, a9
    v_mfma_f32_16x16x32_bf16 v[216:219], a[152:155], a[160:163], v[216:219]
    s_add_u32 s24, s24, 8192
L_LAND1_0:
    s_cbranch_vccnz L_RET
    v_accvgpr_read_b32 v10, a10
    v_accvgpr_read_b32 v11, a11
    v_mfma_f32_16x16x32_bf16 v[216:219], a[156:159], a[164:167], v[216:219]
    s_addc_u32 s25, s25, 0
    v_accvgpr_read_b32 v12, a12
    v_accvgpr_read_b32 v13, a13
    v_mfma_f32_16x16x32_bf16 v[220:223], a[168:171], v[120:123], v[220:223]
    v_accvgpr_read_b32 v14, a14
    v_accvgpr_read_b32 v15, a15
    v_mfma_f32_16x16x32_bf16 v[220:223], a[172:175], v[124:127], v[220:223]
    v_mul_f32 v8, v8, v184
    v_mul_f32 v9, v9, v185
    v_mfma_f32_16x16x32_bf16 v[220:223], a[176:179], a[160:163], v[220:223]
    global_load_dwordx4 a[248:251], v24, s[24:25] offset:-4096 sc1
    v_mul_f32 v10, v10, v186
    v_mfma_f32_16x16x32_bf16 v[220:223], a[180:183], a[164:167], v[220:223]
    v_mul_f32 v11, v11, v187
    v_cvt_pk_bf16_f32 v8, v8, v9
    v_mfma_f32_16x16x32_bf16 v[224:227], a[184:187], v[96:99], v[224:227]
    v_cvt_pk_bf16_f32 v9, v10, v11
    v_mul_f32 v12, v12, v188
    v_mfma_f32_16x16x32_bf16 v[224:227], a[188:191], v[100:103], v[224:227]
    v_mul_f32 v13, v13, v189
    v_mul_f32 v14, v14, v190
    v_mfma_f32_16x16x32_bf16 v[224:227], a[192:195], a[88:91], v[224:227]
    s_waitcnt vmcnt(9) lgkmcnt(0)
    global_load_dwordx4 a[44:47], v24, s[24:25] offset:-3072 sc1
    v_mul_f32 v15, v15, v191
    v_mfma_f32_16x16x32_bf16 v[224:227], a[196:199], a[96:99], v[224:227]
    v_cvt_pk_bf16_f32 v10, v12, v13
    v_cvt_pk_bf16_f32 v11, v14, v15
    v_mfma_f32_16x16x32_bf16 v[228:231], a[200:203], v[96:99], v[228:231]
    v_accvgpr_read_b32 v0, a16
    v_accvgpr_read_b32 v1, a17
    v_mfma_f32_16x16x4_4b_bf16 v[176:191], a[28:29], a[38:39], v[176:191]
    ds_write_b128 v24, v[8:11] offset:7168
    v_accvgpr_read_b32 v2, a18
    v_accvgpr_read_b32 v3, a19
    v_accvgpr_read_b32 v4, a20
    v_mfma_f32_16x16x32_bf16 v[228:231], a[204:207], v[100:103], v[228:231]
    global_load_dwordx4 a[48:51], v24, s[24:25] offset:-2048 sc1
    v_accvgpr_read_b32 v5, a21
    v_mfma_f32_16x16x32_bf16 v[228:231], a[208:211], a[88:91], v[228:231]
    v_accvgpr_read_b32 v6, a22
    v_accvgpr_read_b32 v7, a23
    v_mfma_f32_16x16x32_bf16 v[228:231], a[212:215], a[96:99], v[228:231]
    v_mul_f32 v0, v0, v192
    v_mul_f32 v1, v1, v193
    v_mfma_f32_16x16x32_bf16 v[232:235], a[184:187], v[104:107], v[232:235]
    global_load_dwordx4 a[56:59], v24, s[24:25] offset:-1024 sc1
    v_mul_f32 v2, v2, v194
    v_mfma_f32_16x16x32_bf16 v[232:235], a[188:191], v[108:111], v[232:235]
    v_mul_f32 v3, v3, v195
    v_cvt_pk_bf16_f32 v0, v0, v1
    v_mfma_f32_16x16x32_bf16 v[232:235], a[192:195], a[128:131], v[232:235]
    v_cvt_pk_bf16_f32 v1, v2, v3
    v_mul_f32 v4, v4, v196
    v_mfma_f32_16x16x32_bf16 v[232:235], a[196:199], a[132:135], v[232:235]
    v_mul_f32 v5, v5, v197
    v_mul_f32 v6, v6, v198
    v_mfma_f32_16x16x32_bf16 v[236:239], a[200:203], v[104:107], v[236:239]
    global_load_dwordx4 a[60:63], v24, s[24:25] offset:0 sc1
    v_mul_f32 v7, v7, v199
    v_mfma_f32_16x16x32_bf16 v[236:239], a[204:207], v[108:111], v[236:239]
    v_cvt_pk_bf16_f32 v2, v4, v5
    v_cvt_pk_bf16_f32 v3, v6, v7
    v_mfma_f32_16x16x32_bf16 v[236:239], a[208:211], a[128:131], v[236:239]
    ds_write_b128 v24, v[0:3] offset:8192
    v_mfma_f32_16x16x32_bf16 v[236:239], a[212:215], a[132:135], v[236:239]
    v_mul_f32 v16, v40, v200
    v_mul_f32 v17, v41, v201
    v_mfma_f32_16x16x32_bf16 v[240:243], a[184:187], v[112:115], v[240:243]
    global_load_dwordx4 a[72:75], v24, s[24:25] offset:1024 sc1
    v_mul_f32 v18, v42, v202
    v_mfma_f32_16x16x32_bf16 v[240:243], a[188:191], v[116:119], v[240:243]
    v_mul_f32 v19, v43, v203
    v_cvt_pk_bf16_f32 v16, v16, v17
    v_mfma_f32_16x16x32_bf16 v[240:243], a[192:195], a[144:147], v[240:243]
    v_cvt_pk_bf16_f32 v17, v18, v19
    v_mul_f32 v20, v44, v204
    v_mfma_f32_16x16x32_bf16 v[240:243], a[196:199], a[148:151], v[240:243]
    v_mul_f32 v21, v45, v205
    v_mul_f32 v22, v46, v206
    v_mfma_f32_16x16x32_bf16 v[244:247], a[200:203], v[112:115], v[244:247]
    s_waitcnt vmcnt(9) lgkmcnt(0)
    s_barrier
    v_mfma_f32_16x16x32_bf16 v[244:247], a[204:207], v[116:119], v[244:247]
    ds_read_b128 a[76:79], v24 offset:0
    global_load_dwordx4 a[84:87], v24, s[24:25] offset:2048 sc1
    v_mfma_f32_16x16x32_bf16 v[244:247], a[208:211], a[144:147], v[244:247]
    ds_read_b128 a[92:95], v25 offset:0
    v_mul_f32 v23, v47, v207
    v_mfma_f32_16x16x32_bf16 v[244:247], a[212:215], a[148:151], v[244:247]
    ds_read_b128 a[104:107], v26 offset:0
    v_cvt_pk_bf16_f32 v18, v20, v21
    v_mfma_f32_16x16x32_bf16 v[248:251], a[184:187], v[120:123], v[248:251]
    ds_read_b128 a[108:111], v27 offset:0
    global_load_dwordx4 a[112:115], v24, s[24:25] offset:3072 sc1
    v_mfma_f32_16x16x32_bf16 v[248:251], a[188:191], v[124:127], v[248:251]
    s_add_u32 s24, s24, 8192
    v_cvt_pk_bf16_f32 v19, v22, v23
    v_mul_f32 v8, v48, v208
    v_mfma_f32_16x16x32_bf16 v[248:251], a[192:195], a[160:163], v[248:251]
    s_addc_u32 s25, s25, 0
    v_mul_f32 v9, v49, v209
    v_mul_f32 v10, v50, v210
    v_mfma_f32_16x16x4_4b_bf16 v[192:207], a[30:31], a[36:37], v[192:207]
    ds_write_b128 v24, v[16:19] offset:10240
    v_mul_f32 v11, v51, v211
    v_cvt_pk_bf16_f32 v8, v8, v9
    v_cvt_pk_bf16_f32 v9, v10, v11
    v_mfma_f32_16x16x32_bf16 v[248:251], a[196:199], a[164:167], v[248:251]
    global_load_dwordx4 a[116:119], v24, s[24:25] offset:-4096 sc1
    v_mul_f32 v12, v52, v212
    v_mfma_f32_16x16x32_bf16 v[252:255], a[200:203], v[120:123], v[252:255]
    ds_read_b128 a[40:43], v24 offset:2048
    v_mul_f32 v13, v53, v213
    v_mfma_f32_16x16x32_bf16 v[252:255], a[204:207], v[124:127], v[252:255]
    ds_read_b128 a[52:55], v25 offset:2048
    v_mul_f32 v14, v54, v214
    v_mfma_f32_16x16x32_bf16 v[252:255], a[208:211], a[160:163], v[252:255]
    ds_read_b128 a[64:67], v26 offset:2048
    global_load_dwordx4 a[68:71], v24, s[24:25] offset:-3072 sc1
    v_mfma_f32_16x16x32_bf16 v[252:255], a[212:215], a[164:167], v[252:255]
    s_waitcnt vmcnt(10) lgkmcnt(4)
    ds_read_b128 a[80:83], v27 offset:2048
    v_mul_f32 v15, v55, v215
    v_mfma_f32_16x16x32_bf16 v[96:99], a[216:219], a[76:79], 0
    v_cvt_pk_bf16_f32 v10, v12, v13
    v_cvt_pk_bf16_f32 v11, v14, v15
    v_mfma_f32_16x16x32_bf16 v[96:99], a[220:223], a[92:95], v[96:99]
    ds_write_b128 v24, v[8:11] offset:12288
    v_mfma_f32_16x16x32_bf16 v[96:99], a[224:227], a[104:107], v[96:99]
    global_load_dwordx4 a[100:103], v24, s[24:25] offset:-2048 sc1
    v_mul_f32 v0, v56, v216
    v_mfma_f32_16x16x32_bf16 v[96:99], a[228:231], a[108:111], v[96:99]
    v_mul_f32 v1, v57, v217
    v_mul_f32 v2, v58, v218
    v_mfma_f32_16x16x32_bf16 v[100:103], a[232:235], a[76:79], 0
    ds_read_b128 a[120:123], v24 offset:4096
    v_mul_f32 v3, v59, v219
    v_mfma_f32_16x16x32_bf16 v[100:103], a[236:239], a[92:95], v[100:103]
    ds_read_b128 a[124:127], v25 offset:4096
    v_cvt_pk_bf16_f32 v0, v0, v1
    v_mfma_f32_16x16x32_bf16 v[100:103], a[240:243], a[104:107], v[100:103]
    ds_read_b128 a[136:139], v26 offset:4096
    global_load_dwordx4 a[140:143], v24, s[24:25] offset:-1024 sc1
    v_mfma_f32_16x16x32_bf16 v[100:103], a[244:247], a[108:111], v[100:103]
    s_waitcnt vmcnt(10) lgkmcnt(4)
    ds_read_b128 a[152:155], v27 offset:4096
    v_cvt_pk_bf16_f32 v1, v2, v3
    v_mfma_f32_16x16x32_bf16 v[104:107], a[216:219], a[40:43], 0
    v_mul_f32 v4, v60, v220
    v_mul_f32 v5, v61, v221
    v_mfma_f32_16x16x32_bf16 v[104:107], a[220:223], a[52:55], v[104:107]
    v_mul_f32 v6, v62, v222
    v_mul_f32 v7, v63, v223
    v_mfma_f32_16x16x32_bf16 v[104:107], a[224:227], a[64:67], v[104:107]
    global_load_dwordx4 a[156:159], v24, s[24:25] offset:0 sc1
    v_cvt_pk_bf16_f32 v2, v4, v5
    v_mfma_f32_16x16x32_bf16 v[104:107], a[228:231], a[80:83], v[104:107]
    v_cvt_pk_bf16_f32 v3, v6, v7
    v_mul_f32 v16, v64, v224
    v_mfma_f32_16x16x32_bf16 v[108:111], a[232:235], a[40:43], 0
    ds_read_b128 a[168:171], v24 offset:6144
    v_mul_f32 v17, v65, v225
    v_mfma_f32_16x16x4_4b_bf16 v[208:223], a[30:31], a[36:37], v[208:223]
    ds_write_b128 v24, v[0:3] offset:14336
    v_mul_f32 v18, v66, v226
    v_mul_f32 v19, v67, v227
    v_cvt_pk_bf16_f32 v16, v16, v17
    v_mfma_f32_16x16x32_bf16 v[108:111], a[236:239], a[52:55], v[108:111]
    global_load_dwordx4 a[172:175], v24, s[24:25] offset:1024 sc1
    v_cvt_pk_bf16_f32 v17, v18, v19
    v_mfma_f32_16x16x32_bf16 v[108:111], a[240:243], a[64:67], v[108:111]
    ds_read_b128 a[176:179], v25 offset:6144
    v_mul_f32 v20, v68, v228
    v_mfma_f32_16x16x32_bf16 v[108:111], a[244:247], a[80:83], v[108:111]
    s_waitcnt vmcnt(10) lgkmcnt(3)
    ds_read_b128 a[180:183], v26 offset:6144
    v_mul_f32 v21, v69, v229
    v_mfma_f32_16x16x32_bf16 v[112:115], a[216:219], a[120:123], 0
    ds_read_b128 a[88:91], v27 offset:6144
    global_load_dwordx4 a[96:99], v24, s[24:25] offset:2048 sc1
    v_mfma_f32_16x16x32_bf16 v[112:115], a[220:223], a[124:127], v[112:115]
    v_mul_f32 v22, v70, v230
    v_mul_f32 v23, v71, v231
    v_mfma_f32_16x16x32_bf16 v[112:115], a[224:227], a[136:139], v[112:115]
    v_cvt_pk_bf16_f32 v18, v20, v21
    v_cvt_pk_bf16_f32 v19, v22, v23
    v_mfma_f32_16x16x32_bf16 v[112:115], a[228:231], a[152:155], v[112:115]
    ds_write_b128 v24, v[16:19] offset:9216
    v_mfma_f32_16x16x32_bf16 v[116:119], a[232:235], a[120:123], 0
    global_load_dwordx4 a[128:131], v24, s[24:25] offset:3072 sc1
    v_mul_f32 v8, v72, v232
    v_mfma_f32_16x16x32_bf16 v[116:119], a[236:239], a[124:127], v[116:119]
    s_add_u32 s24, s24, 8192
    v_mul_f32 v9, v73, v233
    v_mul_f32 v10, v74, v234
    v_mfma_f32_16x16x32_bf16 v[116:119], a[240:243], a[136:139], v[116:119]
    s_addc_u32 s25, s25, 0
    ds_read_b128 a[132:135], v24 offset:1024
    ds_read_b128 a[144:147], v25 offset:1024
    v_mfma_f32_16x16x32_bf16 v[116:119], a[244:247], a[152:155], v[116:119]
    s_waitcnt vmcnt(10) lgkmcnt(3)
    ds_read_b128 a[148:151], v26 offset:1024
    v_mul_f32 v11, v75, v235
    v_mfma_f32_16x16x32_bf16 v[120:123], a[216:219], a[168:171], 0
    ds_read_b128 a[184:187], v27 offset:1024
    global_load_dwordx4 a[188:191], v24, s[24:25] offset:-4096 sc1
    v_mfma_f32_16x16x32_bf16 v[120:123], a[220:223], a[176:179], v[120:123]
    v_cvt_pk_bf16_f32 v8, v8, v9
    v_cvt_pk_bf16_f32 v9, v10, v11
    v_mfma_f32_16x16x32_bf16 v[120:123], a[224:227], a[180:183], v[120:123]
    v_mul_f32 v12, v76, v236
    v_mul_f32 v13, v77, v237
    v_mfma_f32_16x16x32_bf16 v[120:123], a[228:231], a[88:91], v[120:123]
    v_mul_f32 v14, v78, v238
    v_mul_f32 v15, v79, v239
    v_mfma_f32_16x16x32_bf16 v[124:127], a[232:235], a[168:171], 0
    ds_read_b128 a[192:195], v24 offset:3072
    global_load_dwordx4 a[196:199], v24, s[24:25] offset:-3072 sc1
    v_mfma_f32_16x16x32_bf16 v[124:127], a[236:239], a[176:179], v[124:127]
    ds_read_b128 a[200:203], v25 offset:3072
    v_cvt_pk_bf16_f32 v10, v12, v13
    v_mfma_f32_16x16x32_bf16 v[124:127], a[240:243], a[180:183], v[124:127]
    ds_read_b128 a[204:207], v26 offset:3072
    v_cvt_pk_bf16_f32 v11, v14, v15
    v_mfma_f32_16x16x32_bf16 v[124:127], a[244:247], a[88:91], v[124:127]
    s_waitcnt vmcnt(9) lgkmcnt(3)
    ds_read_b128 a[208:211], v27 offset:3072
    v_mul_f32 v0, v80, v240
    v_mfma_f32_16x16x4_4b_bf16 v[224:239], a[30:31], a[38:39], v[224:239]
    ds_write_b128 v24, v[8:11] offset:11264
    v_mul_f32 v1, v81, v241
    v_mul_f32 v2, v82, v242
    v_mul_f32 v3, v83, v243
    v_mfma_f32_16x16x32_bf16 v[96:99], a[248:251], a[132:135], v[96:99]
    global_load_dwordx4 a[160:163], v24, s[24:25] offset:-2048 sc1
    v_cvt_pk_bf16_f32 v0, v0, v1
    v_mfma_f32_16x16x32_bf16 v[96:99], a[44:47], a[144:147], v[96:99]
    v_cvt_pk_bf16_f32 v1, v2, v3
    v_mul_f32 v4, v84, v244
    v_mfma_f32_16x16x32_bf16 v[96:99], a[48:51], a[148:151], v[96:99]
    global_load_dwordx4 a[212:215], v24, s[24:25] offset:-1024 sc1
    v_mul_f32 v5, v85, v245
    v_mfma_f32_16x16x32_bf16 v[96:99], a[56:59], a[184:187], v[96:99]
    v_mul_f32 v6, v86, v246
    v_mul_f32 v7, v87, v247
    v_mfma_f32_16x16x32_bf16 v[100:103], a[60:63], a[132:135], v[100:103]
    ds_read_b128 a[164:167], v24 offset:5120
    v_cvt_pk_bf16_f32 v2, v4, v5
    v_mfma_f32_16x16x32_bf16 v[100:103], a[72:75], a[144:147], v[100:103]
    ds_read_b128 a[76:79], v25 offset:5120
    v_cvt_pk_bf16_f32 v3, v6, v7
    v_mfma_f32_16x16x32_bf16 v[100:103], a[84:87], a[148:151], v[100:103]
    ds_write_b128 v24, v[0:3] offset:13312
    v_mfma_f32_16x16x32_bf16 v[100:103], a[112:115], a[184:187], v[100:103]
    s_waitcnt vmcnt(9) lgkmcnt(3)
    global_load_dwordx4 a[92:95], v24, s[24:25] offset:0 sc1
    v_mul_f32 v16, v88, v248
    v_mfma_f32_16x16x32_bf16 v[104:107], a[248:251], a[192:195], v[104:107]
    v_mul_f32 v17, v89, v249
    v_mul_f32 v18, v90, v250
    v_mfma_f32_16x16x32_bf16 v[104:107], a[44:47], a[200:203], v[104:107]
    ds_read_b128 a[104:107], v26 offset:5120
    v_mul_f32 v19, v91, v251
    v_mfma_f32_16x16x32_bf16 v[104:107], a[48:51], a[204:207], v[104:107]
    ds_read_b128 a[108:111], v27 offset:5120
    global_load_dwordx4 a[40:43], v24, s[24:25] offset:1024 sc1
    v_mfma_f32_16x16x32_bf16 v[104:107], a[56:59], a[208:211], v[104:107]
    v_cvt_pk_bf16_f32 v16, v16, v17
    v_cvt_pk_bf16_f32 v17, v18, v19
    v_mfma_f32_16x16x32_bf16 v[108:111], a[60:63], a[192:195], v[108:111]
    ds_read_b128 a[52:55], v24 offset:7168
    v_mul_f32 v20, v92, v252
    v_mfma_f32_16x16x32_bf16 v[108:111], a[72:75], a[200:203], v[108:111]
    ds_read_b128 a[64:67], v25 offset:7168
    v_mul_f32 v21, v93, v253
    v_mfma_f32_16x16x32_bf16 v[108:111], a[84:87], a[204:207], v[108:111]
    ds_read_b128 a[80:83], v26 offset:7168
    global_load_dwordx4 a[120:123], v24, s[24:25] offset:2048 sc1
    v_mfma_f32_16x16x32_bf16 v[108:111], a[112:115], a[208:211], v[108:111]
    s_waitcnt vmcnt(10) lgkmcnt(5)
    ds_read_b128 a[124:127], v27 offset:7168
    v_mul_f32 v22, v94, v254
    v_mfma_f32_16x16x32_bf16 v[112:115], a[248:251], a[164:167], v[112:115]
    v_mul_f32 v23, v95, v255
    v_cvt_pk_bf16_f32 v18, v20, v21
    v_mfma_f32_16x16x32_bf16 v[112:115], a[44:47], a[76:79], v[112:115]
    s_waitcnt vmcnt(9) lgkmcnt(4)
    v_cvt_pk_bf16_f32 v19, v22, v23
    v_subrev_u32 v8, s32, v24
    v_mfma_f32_16x16x32_bf16 v[112:115], a[48:51], a[104:107], v[112:115]
    global_load_dwordx4 a[136:139], v24, s[24:25] offset:3072 sc1
    v_lshrrev_b32 v9, 3, v8
    v_mfma_f32_16x16x4_4b_bf16 v[240:255], a[30:31], a[38:39], v[240:255]
    ds_write_b128 v24, v[16:19] offset:15360
    v_and_b32 v10, 0x70, v8
    v_and_b32 v9, 0x70, v9
    v_lshrrev_b32 v11, 7, v8
    v_mfma_f32_16x16x32_bf16 v[112:115], a[56:59], a[108:111], v[112:115]
    s_add_u32 s24, s24, 8192
    v_xor_b32 v36, v24, v9
    v_lshl_add_u32 v28, v11, 10, v10
    v_mfma_f32_16x16x32_bf16 v[116:119], a[60:63], a[164:167], v[116:119]
    s_addc_u32 s25, s25, 0
    ds_read_b128 a[152:155], v24 offset:8192
    v_bfe_u32 v11, v8, 8, 2
    v_mfma_f32_16x16x32_bf16 v[116:119], a[72:75], a[76:79], v[116:119]
    ds_read_b128 a[216:219], v25 offset:8192
    global_load_dwordx4 a[220:223], v24, s[24:25] offset:-4096 sc1
    v_mfma_f32_16x16x32_bf16 v[116:119], a[84:87], a[104:107], v[116:119]
    ds_read_b128 a[224:227], v26 offset:8192
    v_add_u32 v37, 8192, v28
    v_mfma_f32_16x16x32_bf16 v[116:119], a[112:115], a[108:111], v[116:119]
    s_waitcnt vmcnt(10) lgkmcnt(4)
    ds_read_b128 a[228:231], v27 offset:8192
    v_lshlrev_b32 v11, 4, v11
    v_mfma_f32_16x16x32_bf16 v[120:123], a[248:251], a[52:55], v[120:123]
    global_load_dwordx4 a[232:235], v24, s[24:25] offset:-3072 sc1
    v_and_b32 v9, 0xf0, v8
    v_mfma_f32_16x16x32_bf16 v[120:123], a[44:47], a[64:67], v[120:123]
    v_xor_b32 v11, v11, v10
    v_lshl_add_u32 v11, v9, 3, v11
    v_mfma_f32_16x16x32_bf16 v[120:123], a[48:51], a[80:83], v[120:123]
    v_add_u32 v34, s32, v11
    v_xor_b32 v35, 64, v34
    v_mfma_f32_16x16x32_bf16 v[120:123], a[56:59], a[124:127], v[120:123]
    ds_read_b128 a[168:171], v24 offset:10240
    v_mfma_f32_16x16x32_bf16 v[124:127], a[60:63], a[52:55], v[124:127]
    s_waitcnt vmcnt(9) lgkmcnt(3)
    s_barrier
    v_mfma_f32_16x16x32_bf16 v[124:127], a[72:75], a[64:67], v[124:127]
    ds_read_b128 a[236:239], v25 offset:10240
    global_load_dwordx4 a[176:179], v24, s[24:25] offset:-2048 sc1
    v_mfma_f32_16x16x32_bf16 v[124:127], a[84:87], a[80:83], v[124:127]
    ds_read_b128 a[240:243], v26 offset:10240
    ds_read_b128 a[180:183], v27 offset:10240
    v_mfma_f32_16x16x32_bf16 v[124:127], a[112:115], a[124:127], v[124:127]
    ds_read_b128 a[244:247], v24 offset:12288
    ds_read_b128 a[88:91], v25 offset:12288
    v_mfma_f32_16x16x32_bf16 v[96:99], a[116:119], a[152:155], v[96:99]
    ds_read_b128 a[132:135], v26 offset:12288
    ds_read_b128 a[144:147], v27 offset:12288
    v_mfma_f32_16x16x32_bf16 v[96:99], a[68:71], a[216:219], v[96:99]
    s_waitcnt vmcnt(9) lgkmcnt(8)
    global_load_dwordx4 a[148:151], v24, s[24:25] offset:-1024 sc1
    v_mfma_f32_16x16x32_bf16 v[96:99], a[100:103], a[224:227], v[96:99]
    v_mfma_f32_16x16x32_bf16 v[96:99], a[140:143], a[228:231], v[96:99]
    v_mfma_f32_16x16x32_bf16 v[100:103], a[156:159], a[152:155], v[100:103]
    ds_read_b128 a[184:187], v24 offset:14336
    v_mfma_f32_16x16x32_bf16 v[100:103], a[172:175], a[216:219], v[100:103]
    global_load_dwordx4 a[192:195], v24, s[24:25] offset:0 sc1
    v_mfma_f32_16x16x32_bf16 v[100:103], a[96:99], a[224:227], v[100:103]
    ds_read_b128 a[200:203], v25 offset:14336
    ds_read_b128 a[204:207], v26 offset:14336
    v_mfma_f32_16x16x32_bf16 v[100:103], a[128:131], a[228:231], v[100:103]
    s_waitcnt vmcnt(9) lgkmcnt(3)
    ds_read_b128 a[208:211], v27 offset:14336
    v_mfma_f32_16x16x32_bf16 v[104:107], a[116:119], a[168:171], v[104:107]
    v_mfma_f32_16x16x32_bf16 v[104:107], a[68:71], a[236:239], v[104:107]
    global_load_dwordx4 a[164:167], v24, s[24:25] offset:1024 sc1
    v_mfma_f32_16x16x32_bf16 v[104:107], a[100:103], a[240:243], v[104:107]
    v_mfma_f32_16x16x32_bf16 v[104:107], a[140:143], a[180:183], v[104:107]
    v_mfma_f32_16x16x32_bf16 v[108:111], a[156:159], a[168:171], v[108:111]
    ds_read_b128 a[76:79], v24 offset:9216
    v_mfma_f32_16x16x32_bf16 v[108:111], a[172:175], a[236:239], v[108:111]
    ds_read_b128 a[104:107], v25 offset:9216
    v_mfma_f32_16x16x32_bf16 v[108:111], a[96:99], a[240:243], v[108:111]
    global_load_dwordx4 a[108:111], v24, s[24:25] offset:2048 sc1
    v_mfma_f32_16x16x32_bf16 v[108:111], a[128:131], a[180:183], v[108:111]
    ds_read_b128 a[248:251], v26 offset:9216
    ds_read_b128 a[44:47], v27 offset:9216
    v_mfma_f32_16x16x32_bf16 v[112:115], a[116:119], a[244:247], v[112:115]
    v_mfma_f32_16x16x32_bf16 v[112:115], a[68:71], a[88:91], v[112:115]
    v_mfma_f32_16x16x32_bf16 v[112:115], a[100:103], a[132:135], v[112:115]
    global_load_dwordx4 a[48:51], v24, s[24:25] offset:3072 sc1
    v_mfma_f32_16x16x32_bf16 v[112:115], a[140:143], a[144:147], v[112:115]
    s_add_u32 s24, s24, 8192
    v_mfma_f32_16x16x32_bf16 v[116:119], a[156:159], a[244:247], v[116:119]
    s_addc_u32 s25, s25, 0
    ds_read_b128 a[56:59], v24 offset:11264
    v_mfma_f32_16x16x32_bf16 v[116:119], a[172:175], a[88:91], v[116:119]
    ds_read_b128 a[60:63], v25 offset:11264
    v_mfma_f32_16x16x32_bf16 v[116:119], a[96:99], a[132:135], v[116:119]
    global_load_dwordx4 a[52:55], v24, s[24:25] offset:-4096 sc1
    v_mfma_f32_16x16x32_bf16 v[116:119], a[128:131], a[144:147], v[116:119]
    s_waitcnt vmcnt(9) lgkmcnt(2)
    ds_read_b128 a[72:75], v26 offset:11264
    ds_read_b128 a[64:67], v27 offset:11264
    v_mfma_f32_16x16x32_bf16 v[120:123], a[116:119], a[184:187], v[120:123]
    v_mfma_f32_16x16x32_bf16 v[120:123], a[68:71], a[200:203], v[120:123]
    v_mfma_f32_16x16x32_bf16 v[120:123], a[100:103], a[204:207], v[120:123]
    global_load_dwordx4 a[84:87], v24, s[24:25] offset:-3072 sc1
    v_mfma_f32_16x16x32_bf16 v[120:123], a[140:143], a[208:211], v[120:123]
    v_mfma_f32_16x16x32_bf16 v[124:127], a[156:159], a[184:187], v[124:127]
    ds_read_b128 a[80:83], v24 offset:13312
    v_mfma_f32_16x16x32_bf16 v[124:127], a[172:175], a[200:203], v[124:127]
    ds_read_b128 a[112:115], v25 offset:13312
    v_mfma_f32_16x16x32_bf16 v[124:127], a[96:99], a[204:207], v[124:127]
    ds_read_b128 a[124:127], v26 offset:13312
    v_mfma_f32_16x16x32_bf16 v[124:127], a[128:131], a[208:211], v[124:127]
    global_load_dwordx4 a[152:155], v24, s[24:25] offset:-2048 sc1
    v_mfma_f32_16x16x32_bf16 v[96:99], a[188:191], a[76:79], v[96:99]
    ds_read_b128 a[216:219], v27 offset:13312
    v_mfma_f32_16x16x32_bf16 v[96:99], a[196:199], a[104:107], v[96:99]
    v_mfma_f32_16x16x32_bf16 v[96:99], a[160:163], a[248:251], v[96:99]
    v_mfma_f32_16x16x32_bf16 v[96:99], a[212:215], a[44:47], v[96:99]
    global_load_dwordx4 a[224:227], v24, s[24:25] offset:-1024 sc1
    s_nop 0
    v_mfma_f32_16x16x32_bf16 v[100:103], a[92:95], a[76:79], v[100:103]
    s_nop 1
    v_mfma_f32_16x16x32_bf16 v[100:103], a[40:43], a[104:107], v[100:103]
    s_nop 1
    v_mfma_f32_16x16x32_bf16 v[100:103], a[120:123], a[248:251], v[100:103]
    v_cvt_pk_bf16_f32 v96, v96, v97
    v_cvt_pk_bf16_f32 v97, v98, v99
    v_mfma_f32_16x16x32_bf16 v[100:103], a[136:139], a[44:47], v[100:103]
    s_waitcnt vmcnt(8) lgkmcnt(0)
    global_load_dwordx4 a[228:231], v24, s[24:25] offset:0 sc1
    s_nop 0
    v_mfma_f32_16x16x32_bf16 v[104:107], a[188:191], a[56:59], v[104:107]
    s_nop 1
    v_mfma_f32_16x16x32_bf16 v[104:107], a[196:199], a[60:63], v[104:107]
    s_nop 1
    v_mfma_f32_16x16x32_bf16 v[104:107], a[160:163], a[72:75], v[104:107]
    v_cvt_pk_bf16_f32 v98, v100, v101
    v_cvt_pk_bf16_f32 v99, v102, v103
    v_mfma_f32_16x16x32_bf16 v[104:107], a[212:215], a[64:67], v[104:107]
    ds_write_b128 v24, v[96:99] offset:16384
    v_mfma_f32_16x16x32_bf16 v[108:111], a[92:95], a[56:59], v[108:111]
    global_load_dwordx4 a[168:171], v24, s[24:25] offset:1024 sc1
    s_nop 0
    v_mfma_f32_16x16x32_bf16 v[108:111], a[40:43], a[60:63], v[108:111]
    s_nop 1
    v_mfma_f32_16x16x32_bf16 v[108:111], a[120:123], a[72:75], v[108:111]
    ds_read_b128 a[236:239], v24 offset:15360
    ds_read_b128 a[240:243], v25 offset:15360
    v_mfma_f32_16x16x32_bf16 v[108:111], a[136:139], a[64:67], v[108:111]
    ds_read_b128 a[180:183], v26 offset:15360
    global_load_dwordx4 a[244:247], v24, s[24:25] offset:2048 sc1
    v_mfma_f32_16x16x32_bf16 v[112:115], a[188:191], a[80:83], v[112:115]
    ds_read_b128 a[88:91], v27 offset:15360
    v_cvt_pk_bf16_f32 v104, v104, v105
    v_mfma_f32_16x16x32_bf16 v[112:115], a[196:199], a[112:115], v[112:115]
    ds_read_b128 v[0:3], v24 offset:28672
    v_cvt_pk_bf16_f32 v105, v106, v107
    v_mfma_f32_16x16x32_bf16 v[112:115], a[160:163], a[124:127], v[112:115]
    ds_read_b128 v[4:7], v24 offset:29696
    v_cvt_pk_bf16_f32 v106, v108, v109
    v_mfma_f32_16x16x32_bf16 v[112:115], a[212:215], a[216:219], v[112:115]
    global_load_dwordx4 a[132:135], v24, s[24:25] offset:3072 sc1
    v_cvt_pk_bf16_f32 v107, v110, v111
    v_mfma_f32_16x16x32_bf16 v[116:119], a[92:95], a[80:83], v[116:119]
    s_add_u32 s24, s24, 8192
    ds_write_b128 v24, v[104:107] offset:17408
    v_mfma_f32_16x16x32_bf16 v[116:119], a[40:43], a[112:115], v[116:119]
    s_addc_u32 s25, s25, 0
    s_nop 1
    v_mfma_f32_16x16x32_bf16 v[116:119], a[120:123], a[124:127], v[116:119]
    s_waitcnt vmcnt(8) lgkmcnt(4)
    s_barrier
    v_mfma_f32_16x16x32_bf16 v[116:119], a[136:139], a[216:219], v[116:119]
    ds_read_b128 v[100:103], v25 offset:16384
    global_load_dwordx4 a[144:147], v24, s[24:25] offset:-4096 sc1
    v_mfma_f32_16x16x32_bf16 v[120:123], a[188:191], a[236:239], v[120:123]
    ds_read_b128 a[116:119], v26 offset:16384
    v_cvt_pk_bf16_f32 v112, v112, v113
    v_mfma_f32_16x16x32_bf16 v[120:123], a[196:199], a[240:243], v[120:123]
    ds_read_b128 a[68:71], v27 offset:16384
    v_cvt_pk_bf16_f32 v113, v114, v115
    v_mfma_f32_16x16x32_bf16 v[120:123], a[160:163], a[180:183], v[120:123]
    s_waitcnt vmcnt(8) lgkmcnt(4)
    ds_read_b128 v[16:19], v24 offset:30720
    v_cvt_pk_bf16_f32 v114, v116, v117
    v_mfma_f32_16x16x32_bf16 v[120:123], a[212:215], a[88:91], v[120:123]
    ds_read_b128 v[20:23], v24 offset:31744
    global_load_dwordx4 a[100:103], v24, s[24:25] offset:-3072 sc1
    v_mfma_f32_16x16x32_bf16 v[124:127], a[92:95], a[236:239], v[124:127]
    v_cvt_pk_bf16_f32 v115, v118, v119
    s_nop 0
    v_mfma_f32_16x16x32_bf16 v[124:127], a[40:43], a[240:243], v[124:127]
    ds_write_b128 v24, v[112:115] offset:18432
    v_mfma_f32_16x16x32_bf16 v[124:127], a[120:123], a[180:183], v[124:127]
    s_waitcnt vmcnt(8) lgkmcnt(5)
    s_barrier
    v_mfma_f32_16x16x32_bf16 v[124:127], a[136:139], a[88:91], v[124:127]
    global_load_dwordx4 a[140:143], v24, s[24:25] offset:-2048 sc1
    v_cvt_pk_bf16_f32 v120, v120, v121
    v_mfma_f32_16x16x32_bf16 v[128:131], a[220:223], v[96:99], v[128:131]
    ds_read_b128 v[108:111], v25 offset:17408
    v_cvt_pk_bf16_f32 v121, v122, v123
    v_mfma_f32_16x16x32_bf16 v[128:131], a[232:235], v[100:103], v[128:131]
    s_waitcnt lgkmcnt(3)
    ds_read_b128 a[156:159], v26 offset:17408
    v_cvt_pk_bf16_f32 v122, v124, v125
    v_mfma_f32_16x16x32_bf16 v[128:131], a[176:179], a[116:119], v[128:131]
    ds_read_b128 a[184:187], v27 offset:17408
    v_cvt_pk_bf16_f32 v123, v126, v127
    v_mfma_f32_16x16x32_bf16 v[128:131], a[148:151], a[68:71], v[128:131]
    ds_write_b128 v24, v[120:123] offset:19456
    v_mfma_f32_16x16x32_bf16 v[132:135], a[192:195], v[96:99], v[132:135]
    global_load_dwordx4 a[172:175], v24, s[24:25] offset:-1024 sc1
    v_mfma_f32_16x16x32_bf16 v[132:135], a[164:167], v[100:103], v[132:135]
    v_mfma_f32_16x16x32_bf16 v[132:135], a[108:111], a[116:119], v[132:135]
    s_waitcnt vmcnt(9) lgkmcnt(0)
    s_barrier
    v_mfma_f32_16x16x32_bf16 v[132:135], a[48:51], a[68:71], v[132:135]
    ds_read_b128 v[116:119], v25 offset:18432
    global_load_dwordx4 a[200:203], v24, s[24:25] offset:0 sc1
    v_mfma_f32_16x16x32_bf16 v[136:139], a[220:223], v[104:107], v[136:139]
    ds_read_b128 a[96:99], v26 offset:18432
    v_mul_f32 v0, v0, v128
    v_mfma_f32_16x16x32_bf16 v[136:139], a[232:235], v[108:111], v[136:139]
    ds_read_b128 a[204:207], v27 offset:18432
    v_mul_f32 v1, v1, v129
    v_mfma_f32_16x16x32_bf16 v[136:139], a[176:179], a[156:159], v[136:139]
    ds_read_b128 v[8:11], v24 offset:32768
    global_load_dwordx4 a[128:131], v24, s[24:25] offset:1024 sc1
    v_mfma_f32_16x16x32_bf16 v[136:139], a[148:151], a[184:187], v[136:139]
    ds_read_b128 v[12:15], v24 offset:33792
    v_mul_f32 v2, v2, v130
    v_mfma_f32_16x16x32_bf16 v[140:143], a[192:195], v[104:107], v[140:143]
    v_mul_f32 v3, v3, v131
    v_cvt_pk_bf16_f32 v0, v0, v1
    v_mfma_f32_16x16x32_bf16 v[140:143], a[164:167], v[108:111], v[140:143]
    v_cvt_pk_bf16_f32 v1, v2, v3
    v_mul_f32 v4, v4, v132
    v_mfma_f32_16x16x32_bf16 v[140:143], a[108:111], a[156:159], v[140:143]
    v_mul_f32 v5, v5, v133
    v_mul_f32 v6, v6, v134
    v_mfma_f32_16x16x32_bf16 v[140:143], a[48:51], a[184:187], v[140:143]
    ds_read_b128 v[124:127], v25 offset:19456
    global_load_dwordx4 a[208:211], v24, s[24:25] offset:2048 sc1
    v_mfma_f32_16x16x32_bf16 v[144:147], a[220:223], v[112:115], v[144:147]
    s_waitcnt vmcnt(9) lgkmcnt(3)
    ds_read_b128 a[76:79], v26 offset:19456
    v_mul_f32 v7, v7, v135
    v_mfma_f32_16x16x32_bf16 v[144:147], a[232:235], v[116:119], v[144:147]
    ds_read_b128 a[104:107], v27 offset:19456
    v_cvt_pk_bf16_f32 v2, v4, v5
    v_mfma_f32_16x16x32_bf16 v[144:147], a[176:179], a[96:99], v[144:147]
    v_cvt_pk_bf16_f32 v3, v6, v7
    v_mul_f32 v16, v16, v136
    v_mfma_f32_16x16x32_bf16 v[144:147], a[148:151], a[204:207], v[144:147]
    ds_write_b128 v24, v[0:3] offset:0
    v_mfma_f32_16x16x32_bf16 v[148:151], a[192:195], v[112:115], v[148:151]
    global_load_dwordx4 a[248:251], v24, s[24:25] offset:3072 sc1
    v_mul_f32 v17, v17, v137
    v_mfma_f32_16x16x32_bf16 v[148:151], a[164:167], v[116:119], v[148:151]
    s_add_u32 s24, s24, 8192
    v_mul_f32 v18, v18, v138
    v_mul_f32 v19, v19, v139
    v_mfma_f32_16x16x32_bf16 v[148:151], a[108:111], a[96:99], v[148:151]
    s_addc_u32 s25, s25, 0
    v_cvt_pk_bf16_f32 v16, v16, v17
    v_cvt_pk_bf16_f32 v17, v18, v19
    v_mfma_f32_16x16x32_bf16 v[148:151], a[48:51], a[204:207], v[148:151]
    global_load_dwordx4 a[44:47], v24, s[24:25] offset:-4096 sc1
    v_mul_f32 v20, v20, v140
    v_mfma_f32_16x16x32_bf16 v[152:155], a[220:223], v[120:123], v[152:155]
    s_waitcnt vmcnt(9) lgkmcnt(1)
    v_mul_f32 v21, v21, v141
    v_mul_f32 v22, v22, v142
    v_mfma_f32_16x16x32_bf16 v[152:155], a[232:235], v[124:127], v[152:155]
    v_mul_f32 v23, v23, v143
    v_cvt_pk_bf16_f32 v18, v20, v21
    v_mfma_f32_16x16x32_bf16 v[152:155], a[176:179], a[76:79], v[152:155]
    v_cvt_pk_bf16_f32 v19, v22, v23
    v_mul_f32 v8, v8, v144
    v_mfma_f32_16x16x32_bf16 v[152:155], a[148:151], a[104:107], v[152:155]
    global_load_dwordx4 a[56:59], v24, s[24:25] offset:-3072 sc1
    v_mul_f32 v9, v9, v145
    v_mfma_f32_16x16x4_4b_bf16 v[128:143], a[32:33], a[36:37], v[128:143]
    ds_write_b128 v24, v[16:19] offset:2048
    v_mul_f32 v10, v10, v146
    v_mul_f32 v11, v11, v147
    v_cvt_pk_bf16_f32 v8, v8, v9
    v_mfma_f32_16x16x32_bf16 v[156:159], a[192:195], v[120:123], v[156:159]
    global_load_dwordx4 a[60:63], v24, s[24:25] offset:-2048 sc1
    v_cvt_pk_bf16_f32 v9, v10, v11
    v_mfma_f32_16x16x32_bf16 v[156:159], a[164:167], v[124:127], v[156:159]
    ds_read_b128 v[16:19], v24 offset:34816
L_LAND2_0:
    s_cbranch_vccnz L_RET
    v_mul_f32 v12, v12, v148
    v_mfma_f32_16x16x32_bf16 v[156:159], a[108:111], a[76:79], v[156:159]
    ds_read_b128 v[20:23], v24 offset:35840
    v_mul_f32 v13, v13, v149
    v_mfma_f32_16x16x32_bf16 v[156:159], a[48:51], a[104:107], v[156:159]
    v_mul_f32 v14, v14, v150
    v_mul_f32 v15, v15, v151
    v_mfma_f32_16x16x32_bf16 v[160:163], a[52:55], v[96:99], v[160:163]
    v_cvt_pk_bf16_f32 v10, v12, v13
    v_cvt_pk_bf16_f32 v11, v14, v15
    v_mfma_f32_16x16x32_bf16 v[160:163], a[84:87], v[100:103], v[160:163]
    ds_write_b128 v24, v[8:11] offset:4096
    v_mfma_f32_16x16x32_bf16 v[160:163], a[152:155], a[116:119], v[160:163]
    global_load_dwordx4 a[72:75], v24, s[24:25] offset:-1024 sc1
    v_accvgpr_read_b32 v0, a0
    v_mfma_f32_16x16x32_bf16 v[160:163], a[224:227], a[68:71], v[160:163]
    v_accvgpr_read_b32 v1, a1
    v_accvgpr_read_b32 v2, a2
    v_mfma_f32_16x16x32_bf16 v[164:167], a[228:231], v[96:99], v[164:167]
    ds_read_b128 v[8:11], v24 offset:36864
    global_load_dwordx4 a[64:67], v24, s[24:25] offset:0 sc1
    v_mfma_f32_16x16x32_bf16 v[164:167], a[168:171], v[100:103], v[164:167]
    ds_read_b128 v[12:15], v24 offset:37888
    v_accvgpr_read_b32 v3, a3
    v_mfma_f32_16x16x32_bf16 v[164:167], a[244:247], a[116:119], v[164:167]
    v_accvgpr_read_b32 v4, a4
    v_accvgpr_read_b32 v5, a5
    v_mfma_f32_16x16x32_bf16 v[164:167], a[132:135], a[68:71], v[164:167]
    v_accvgpr_read_b32 v6, a6
    v_accvgpr_read_b32 v7, a7
    v_mfma_f32_16x16x32_bf16 v[168:171], a[52:55], v[104:107], v[168:171]
    global_load_dwordx4 a[80:83], v24, s[24:25] offset:1024 sc1
    v_mul_f32 v0, v0, v152
    v_mfma_f32_16x16x32_bf16 v[168:171], a[84:87], v[108:111], v[168:171]
    v_mul_f32 v1, v1, v153
    v_mul_f32 v2, v2, v154
    v_mfma_f32_16x16x32_bf16 v[168:171], a[152:155], a[156:159], v[168:171]
    v_mul_f32 v3, v3, v155
    v_cvt_pk_bf16_f32 v0, v0, v1
    v_mfma_f32_16x16x32_bf16 v[168:171], a[224:227], a[184:187], v[168:171]
    v_cvt_pk_bf16_f32 v1, v2, v3
    v_mul_f32 v4, v4, v156
    v_mfma_f32_16x16x32_bf16 v[172:175], a[228:231], v[104:107], v[172:175]
    v_mul_f32 v5, v5, v157
    v_mul_f32 v6, v6, v158
    v_mfma_f32_16x16x32_bf16 v[172:175], a[168:171], v[108:111], v[172:175]
    global_load_dwordx4 a[112:115], v24, s[24:25] offset:2048 sc1
    v_mul_f32 v7, v7, v159
    v_mfma_f32_16x16x32_bf16 v[172:175], a[244:247], a[156:159], v[172:175]
    v_cvt_pk_bf16_f32 v2, v4, v5
    v_cvt_pk_bf16_f32 v3, v6, v7
    v_mfma_f32_16x16x32_bf16 v[172:175], a[132:135], a[184:187], v[172:175]
    s_waitcnt vmcnt(9) lgkmcnt(0)
    v_mul_f32 v16, v16, v160
    v_mul_f32 v17, v17, v161
    v_mfma_f32_16x16x4_4b_bf16 v[144:159], a[32:33], a[36:37], v[144:159]
    ds_write_b128 v24, v[0:3] offset:6144
    v_mul_f32 v18, v18, v162
    v_mul_f32 v19, v19, v163
    v_cvt_pk_bf16_f32 v16, v16, v17
    v_mfma_f32_16x16x32_bf16 v[176:179], a[52:55], v[112:115], v[176:179]
    global_load_dwordx4 a[124:127], v24, s[24:25] offset:3072 sc1
    v_cvt_pk_bf16_f32 v17, v18, v19
    v_mfma_f32_16x16x32_bf16 v[176:179], a[84:87], v[116:119], v[176:179]
    s_add_u32 s24, s24, 8192
    ds_read_b128 v[0:3], v24 offset:38912
    v_mul_f32 v20, v20, v164
    v_mfma_f32_16x16x32_bf16 v[176:179], a[152:155], a[96:99], v[176:179]
    s_addc_u32 s25, s25, 0
    ds_read_b128 v[4:7], v24 offset:39936
    v_mul_f32 v21, v21, v165
    v_mfma_f32_16x16x32_bf16 v[176:179], a[224:227], a[204:207], v[176:179]
    global_load_dwordx4 a[216:219], v24, s[24:25] offset:-4096 sc1
    v_mul_f32 v22, v22, v166
    v_mfma_f32_16x16x32_bf16 v[180:183], a[228:231], v[112:115], v[180:183]
    v_mul_f32 v23, v23, v167
    v_cvt_pk_bf16_f32 v18, v20, v21
    v_mfma_f32_16x16x32_bf16 v[180:183], a[168:171], v[116:119], v[180:183]
    v_cvt_pk_bf16_f32 v19, v22, v23
    v_mul_f32 v8, v8, v168
    v_mfma_f32_16x16x32_bf16 v[180:183], a[244:247], a[96:99], v[180:183]
    ds_write_b128 v24, v[16:19] offset:1024
    v_mfma_f32_16x16x32_bf16 v[180:183], a[132:135], a[204:207], v[180:183]
    global_load_dwordx4 a[188:191], v24, s[24:25] offset:-3072 sc1
    v_mul_f32 v9, v9, v169
    v_mfma_f32_16x16x32_bf16 v[184:187], a[52:55], v[120:123], v[184:187]
    v_mul_f32 v10, v10, v170
    v_mul_f32 v11, v11, v171
    v_mfma_f32_16x16x32_bf16 v[184:187], a[84:87], v[124:127], v[184:187]
    v_cvt_pk_bf16_f32 v8, v8, v9
    v_cvt_pk_bf16_f32 v9, v10, v11
    v_mfma_f32_16x16x32_bf16 v[184:187], a[152:155], a[76:79], v[184:187]
    global_load_dwordx4 a[196:199], v24, s[24:25] offset:-2048 sc1
    v_mul_f32 v12, v12, v172
    v_mfma_f32_16x16x32_bf16 v[184:187], a[224:227], a[104:107], v[184:187]
    v_mul_f32 v13, v13, v173
    v_mul_f32 v14, v14, v174
    v_mfma_f32_16x16x32_bf16 v[188:191], a[228:231], v[120:123], v[188:191]
    v_mul_f32 v15, v15, v175
    v_cvt_pk_bf16_f32 v10, v12, v13
    v_mfma_f32_16x16x32_bf16 v[188:191], a[168:171], v[124:127], v[188:191]
    v_cvt_pk_bf16_f32 v11, v14, v15
    v_mfma_f32_16x16x32_bf16 v[188:191], a[244:247], a[76:79], v[188:191]
    s_waitcnt vmcnt(10) lgkmcnt(0)
    v_mul_f32 v0, v0, v176
    v_mul_f32 v1, v1, v177
    v_mfma_f32_16x16x4_4b_bf16 v[160:175], a[32:33], a[38:39], v[160:175]
    ds_write_b128 v24, v[8:11] offset:3072
    v_mul_f32 v2, v2, v178
    v_mul_f32 v3, v3, v179
    v_cvt_pk_bf16_f32 v0, v0, v1
    v_mfma_f32_16x16x32_bf16 v[188:191], a[132:135], a[104:107], v[188:191]
    global_load_dwordx4 a[160:163], v24, s[24:25] offset:-1024 sc1
    v_cvt_pk_bf16_f32 v1, v2, v3
    v_mfma_f32_16x16x32_bf16 v[192:195], a[144:147], v[96:99], v[192:195]
    global_load_dwordx4 a[212:215], v24, s[24:25] offset:0 sc1
    v_mul_f32 v4, v4, v180
    v_mfma_f32_16x16x32_bf16 v[192:195], a[100:103], v[100:103], v[192:195]
    v_mul_f32 v5, v5, v181
    v_mul_f32 v6, v6, v182
    v_mfma_f32_16x16x32_bf16 v[192:195], a[140:143], a[116:119], v[192:195]
    v_mul_f32 v7, v7, v183
    v_cvt_pk_bf16_f32 v2, v4, v5
    v_mfma_f32_16x16x32_bf16 v[192:195], a[172:175], a[68:71], v[192:195]
    v_cvt_pk_bf16_f32 v3, v6, v7
    v_accvgpr_read_b32 v16, a8
    v_mfma_f32_16x16x32_bf16 v[196:199], a[200:203], v[96:99], v[196:199]
    ds_write_b128 v24, v[0:3] offset:5120
    v_mfma_f32_16x16x32_bf16 v[196:199], a[128:131], v[100:103], v[196:199]
    global_load_dwordx4 a[92:95], v24, s[24:25] offset:1024 sc1
    v_accvgpr_read_b32 v17, a9
    v_mfma_f32_16x16x32_bf16 v[196:199], a[208:211], a[116:119], v[196:199]
    v_accvgpr_read_b32 v18, a10
    v_accvgpr_read_b32 v19, a11
    v_mfma_f32_16x16x32_bf16 v[196:199], a[248:251], a[68:71], v[196:199]
    v_accvgpr_read_b32 v20, a12
    v_accvgpr_read_b32 v21, a13
    v_mfma_f32_16x16x32_bf16 v[200:203], a[144:147], v[104:107], v[200:203]
    global_load_dwordx4 a[236:239], v24, s[24:25] offset:2048 sc1
    v_accvgpr_read_b32 v22, a14
    v_mfma_f32_16x16x32_bf16 v[200:203], a[100:103], v[108:111], v[200:203]
    v_accvgpr_read_b32 v23, a15
    v_mul_f32 v16, v16, v184
    v_mfma_f32_16x16x32_bf16 v[200:203], a[140:143], a[156:159], v[200:203]
    v_mul_f32 v17, v17, v185
    v_mul_f32 v18, v18, v186
    v_mfma_f32_16x16x32_bf16 v[200:203], a[172:175], a[184:187], v[200:203]
    v_mul_f32 v19, v19, v187
    v_cvt_pk_bf16_f32 v16, v16, v17
    v_mfma_f32_16x16x32_bf16 v[204:207], a[200:203], v[104:107], v[204:207]
    global_load_dwordx4 a[40:43], v24, s[24:25] offset:3072 sc1
    v_cvt_pk_bf16_f32 v17, v18, v19
    v_mfma_f32_16x16x32_bf16 v[204:207], a[128:131], v[108:111], v[204:207]
    s_add_u32 s24, s24, 8192
    v_mul_f32 v20, v20, v188
    v_mul_f32 v21, v21, v189
    v_mfma_f32_16x16x32_bf16 v[204:207], a[208:211], a[156:159], v[204:207]
    s_addc_u32 s25, s25, 0
    v_mul_f32 v22, v22, v190
    v_mul_f32 v23, v23, v191
    v_mfma_f32_16x16x32_bf16 v[204:207], a[248:251], a[184:187], v[204:207]
    v_cvt_pk_bf16_f32 v18, v20, v21
    v_cvt_pk_bf16_f32 v19, v22, v23
    v_mfma_f32_16x16x32_bf16 v[208:211], a[144:147], v[112:115], v[208:211]
    v_accvgpr_read_b32 v8, a16
    v_accvgpr_read_b32 v9, a17
    v_mfma_f32_16x16x4_4b_bf16 v[176:191], a[32:33], a[38:39], v[176:191]
    ds_write_b128 v24, v[16:19] offset:7168
    v_accvgpr_read_b32 v10, a18
    v_accvgpr_read_b32 v11, a19
    v_accvgpr_read_b32 v12, a20
    v_mfma_f32_16x16x32_bf16 v[208:211], a[100:103], v[116:119], v[208:211]
    global_load_dwordx4 a[240:243], v24, s[24:25] offset:-4096 sc1
    v_accvgpr_read_b32 v13, a21
    v_mfma_f32_16x16x32_bf16 v[208:211], a[140:143], a[96:99], v[208:211]
    global_load_dwordx4 a[120:123], v24, s[24:25] offset:-3072 sc1
    v_accvgpr_read_b32 v14, a22
    v_mfma_f32_16x16x32_bf16 v[208:211], a[172:175], a[204:207], v[208:211]
    v_accvgpr_read_b32 v15, a23
    v_mul_f32 v8, v8, v192
    v_mfma_f32_16x16x32_bf16 v[212:215], a[200:203], v[112:115], v[212:215]
    v_mul_f32 v9, v9, v193
    v_mul_f32 v10, v10, v194
    v_mfma_f32_16x16x32_bf16 v[212:215], a[128:131], v[116:119], v[212:215]
    v_mul_f32 v11, v11, v195
    v_cvt_pk_bf16_f32 v8, v8, v9
    v_mfma_f32_16x16x32_bf16 v[212:215], a[208:211], a[96:99], v[212:215]
    v_cvt_pk_bf16_f32 v9, v10, v11
    v_mul_f32 v12, v12, v196
    v_mfma_f32_16x16x32_bf16 v[212:215], a[248:251], a[204:207], v[212:215]
    global_load_dwordx4 a[180:183], v24, s[24:25] offset:-2048 sc1
    v_mul_f32 v13, v13, v197
    v_mfma_f32_16x16x32_bf16 v[216:219], a[144:147], v[120:123], v[216:219]
    v_mul_f32 v14, v14, v198
    v_mul_f32 v15, v15, v199
    v_mfma_f32_16x16x32_bf16 v[216:219], a[100:103], v[124:127], v[216:219]
    v_cvt_pk_bf16_f32 v10, v12, v13
    v_cvt_pk_bf16_f32 v11, v14, v15
    v_mfma_f32_16x16x32_bf16 v[216:219], a[140:143], a[76:79], v[216:219]
    ds_write_b128 v24, v[8:11] offset:8192
    v_mfma_f32_16x16x32_bf16 v[216:219], a[172:175], a[104:107], v[216:219]
    global_load_dwordx4 a[136:139], v24, s[24:25] offset:-1024 sc1
    v_mul_f32 v0, v40, v200
    v_mfma_f32_16x16x32_bf16 v[220:223], a[200:203], v[120:123], v[220:223]
    v_mul_f32 v1, v41, v201
    v_mul_f32 v2, v42, v202
    v_mfma_f32_16x16x32_bf16 v[220:223], a[128:131], v[124:127], v[220:223]
    v_mul_f32 v3, v43, v203
    v_cvt_pk_bf16_f32 v0, v0, v1
    v_mfma_f32_16x16x32_bf16 v[220:223], a[208:211], a[76:79], v[220:223]
    global_load_dwordx4 a[88:91], v24, s[24:25] offset:0 sc1
    v_cvt_pk_bf16_f32 v1, v2, v3
    v_mfma_f32_16x16x32_bf16 v[220:223], a[248:251], a[104:107], v[220:223]
    v_mul_f32 v4, v44, v204
    v_mul_f32 v5, v45, v205
    v_mfma_f32_16x16x32_bf16 v[224:227], a[44:47], v[96:99], v[224:227]
    s_waitcnt vmcnt(10) lgkmcnt(1)
    v_mul_f32 v6, v46, v206
    v_mul_f32 v7, v47, v207
    v_mfma_f32_16x16x32_bf16 v[224:227], a[56:59], v[100:103], v[224:227]
    v_cvt_pk_bf16_f32 v2, v4, v5
    v_cvt_pk_bf16_f32 v3, v6, v7
    v_mfma_f32_16x16x32_bf16 v[224:227], a[60:63], a[116:119], v[224:227]
    v_mul_f32 v16, v48, v208
    v_mul_f32 v17, v49, v209
    v_mfma_f32_16x16x4_4b_bf16 v[192:207], a[34:35], a[36:37], v[192:207]
    ds_write_b128 v24, v[0:3] offset:10240
    v_mul_f32 v18, v50, v210
    v_mul_f32 v19, v51, v211
    v_cvt_pk_bf16_f32 v16, v16, v17
    v_mfma_f32_16x16x32_bf16 v[224:227], a[72:75], a[68:71], v[224:227]
    global_load_dwordx4 a[220:223], v24, s[24:25] offset:1024 sc1
    v_cvt_pk_bf16_f32 v17, v18, v19
    v_mfma_f32_16x16x32_bf16 v[228:231], a[64:67], v[96:99], v[228:231]
    global_load_dwordx4 a[232:235], v24, s[24:25] offset:2048 sc1
    v_mul_f32 v20, v52, v212
    v_mfma_f32_16x16x32_bf16 v[228:231], a[80:83], v[100:103], v[228:231]
    v_mul_f32 v21, v53, v213
    v_mul_f32 v22, v54, v214
    v_mfma_f32_16x16x32_bf16 v[228:231], a[112:115], a[116:119], v[228:231]
    v_mul_f32 v23, v55, v215
    v_cvt_pk_bf16_f32 v18, v20, v21
    v_mfma_f32_16x16x32_bf16 v[228:231], a[124:127], a[68:71], v[228:231]
    v_cvt_pk_bf16_f32 v19, v22, v23
    v_mul_f32 v8, v56, v216
    v_mfma_f32_16x16x32_bf16 v[232:235], a[44:47], v[104:107], v[232:235]
    ds_write_b128 v24, v[16:19] offset:12288
    v_mfma_f32_16x16x32_bf16 v[232:235], a[56:59], v[108:111], v[232:235]
    global_load_dwordx4 a[176:179], v24, s[24:25] offset:3072 sc1
    v_mul_f32 v9, v57, v217
    v_mfma_f32_16x16x32_bf16 v[232:235], a[60:63], a[156:159], v[232:235]
    s_add_u32 s24, s24, 8192
    v_mul_f32 v10, v58, v218
    v_mul_f32 v11, v59, v219
    v_mfma_f32_16x16x32_bf16 v[232:235], a[72:75], a[184:187], v[232:235]
    s_addc_u32 s25, s25, 0
    v_cvt_pk_bf16_f32 v8, v8, v9
    v_cvt_pk_bf16_f32 v9, v10, v11
    v_mfma_f32_16x16x32_bf16 v[236:239], a[64:67], v[104:107], v[236:239]
    global_load_dwordx4 a[148:151], v24, s[24:25] offset:-4096 sc1
    v_mul_f32 v12, v60, v220
    v_mfma_f32_16x16x32_bf16 v[236:239], a[80:83], v[108:111], v[236:239]
    v_mul_f32 v13, v61, v221
    v_mul_f32 v14, v62, v222
    v_mfma_f32_16x16x32_bf16 v[236:239], a[112:115], a[156:159], v[236:239]
    v_mul_f32 v15, v63, v223
    v_cvt_pk_bf16_f32 v10, v12, v13
    v_mfma_f32_16x16x32_bf16 v[236:239], a[124:127], a[184:187], v[236:239]
    v_cvt_pk_bf16_f32 v11, v14, v15
    v_mul_f32 v0, v64, v224
    v_mfma_f32_16x16x32_bf16 v[240:243], a[44:47], v[112:115], v[240:243]
    global_load_dwordx4 a[192:195], v24, s[24:25] offset:-3072 sc1
    v_mul_f32 v1, v65, v225
    v_mfma_f32_16x16x4_4b_bf16 v[208:223], a[34:35], a[36:37], v[208:223]
    ds_write_b128 v24, v[8:11] offset:14336
    v_mul_f32 v2, v66, v226
    v_mul_f32 v3, v67, v227
    v_cvt_pk_bf16_f32 v0, v0, v1
    v_mfma_f32_16x16x32_bf16 v[240:243], a[56:59], v[116:119], v[240:243]
    v_cvt_pk_bf16_f32 v1, v2, v3
    v_mul_f32 v4, v68, v228
    v_mfma_f32_16x16x32_bf16 v[240:243], a[60:63], a[96:99], v[240:243]
    global_load_dwordx4 a[164:167], v24, s[24:25] offset:-2048 sc1
    v_mul_f32 v5, v69, v229
    v_mfma_f32_16x16x32_bf16 v[240:243], a[72:75], a[204:207], v[240:243]
    v_mul_f32 v6, v70, v230
    v_mul_f32 v7, v71, v231
    v_mfma_f32_16x16x32_bf16 v[244:247], a[64:67], v[112:115], v[244:247]
    s_waitcnt vmcnt(11) lgkmcnt(0)
    s_barrier
    v_mfma_f32_16x16x32_bf16 v[244:247], a[80:83], v[116:119], v[244:247]
    ds_read_b128 a[108:111], v24 offset:0
    v_cvt_pk_bf16_f32 v2, v4, v5
    v_mfma_f32_16x16x32_bf16 v[244:247], a[112:115], a[96:99], v[244:247]
    ds_read_b128 a[48:51], v25 offset:0
    global_load_dwordx4 a[52:55], v24, s[24:25] offset:-1024 sc1
    v_mfma_f32_16x16x32_bf16 v[244:247], a[124:127], a[204:207], v[244:247]
    ds_read_b128 a[84:87], v26 offset:0
    v_cvt_pk_bf16_f32 v3, v6, v7
    v_mfma_f32_16x16x32_bf16 v[248:251], a[44:47], v[120:123], v[248:251]
    ds_write_b128 v24, v[0:3] offset:9216
    v_mfma_f32_16x16x32_bf16 v[248:251], a[56:59], v[124:127], v[248:251]
    v_mul_f32 v16, v72, v232
    v_mul_f32 v17, v73, v233
    v_mfma_f32_16x16x32_bf16 v[248:251], a[60:63], a[76:79], v[248:251]
    global_load_dwordx4 a[152:155], v24, s[24:25] offset:0 sc1
    v_mul_f32 v18, v74, v234
    v_mfma_f32_16x16x32_bf16 v[248:251], a[72:75], a[104:107], v[248:251]
    ds_read_b128 a[224:227], v27 offset:0
    v_mul_f32 v19, v75, v235
    v_mfma_f32_16x16x32_bf16 v[252:255], a[64:67], v[120:123], v[252:255]
    ds_read_b128 a[228:231], v24 offset:2048
    v_cvt_pk_bf16_f32 v16, v16, v17
    v_mfma_f32_16x16x32_bf16 v[252:255], a[80:83], v[124:127], v[252:255]
    ds_read_b128 a[168:171], v25 offset:2048
    v_cvt_pk_bf16_f32 v17, v18, v19
    v_mfma_f32_16x16x32_bf16 v[252:255], a[112:115], a[76:79], v[252:255]
    ds_read_b128 a[244:247], v26 offset:2048
    global_load_dwordx4 a[132:135], v24, s[24:25] offset:1024 sc1
    v_mfma_f32_16x16x32_bf16 v[252:255], a[124:127], a[104:107], v[252:255]
    s_waitcnt vmcnt(10) lgkmcnt(4)
    ds_read_b128 a[144:147], v27 offset:2048
    v_mul_f32 v20, v76, v236
    v_mfma_f32_16x16x32_bf16 v[96:99], a[216:219], a[108:111], 0
    v_mul_f32 v21, v77, v237
    v_mul_f32 v22, v78, v238
    v_mfma_f32_16x16x32_bf16 v[96:99], a[188:191], a[48:51], v[96:99]
    v_mul_f32 v23, v79, v239
    v_cvt_pk_bf16_f32 v18, v20, v21
    v_mfma_f32_16x16x32_bf16 v[96:99], a[196:199], a[84:87], v[96:99]
    s_waitcnt vmcnt(9) lgkmcnt(4)
    global_load_dwordx4 a[100:103], v24, s[24:25] offset:2048 sc1
    v_cvt_pk_bf16_f32 v19, v22, v23
    v_mfma_f32_16x16x32_bf16 v[96:99], a[160:163], a[224:227], v[96:99]
    v_mul_f32 v8, v80, v240
    v_mul_f32 v9, v81, v241
    v_mfma_f32_16x16x4_4b_bf16 v[224:239], a[34:35], a[38:39], v[224:239]
    ds_write_b128 v24, v[16:19] offset:11264
    v_mul_f32 v10, v82, v242
    v_mul_f32 v11, v83, v243
    v_cvt_pk_bf16_f32 v8, v8, v9
    v_mfma_f32_16x16x32_bf16 v[100:103], a[212:215], a[108:111], 0
    global_load_dwordx4 a[140:143], v24, s[24:25] offset:3072 sc1
    v_cvt_pk_bf16_f32 v9, v10, v11
    v_mfma_f32_16x16x32_bf16 v[100:103], a[92:95], a[48:51], v[100:103]
    s_add_u32 s24, s24, 8192
    ds_read_b128 a[172:175], v24 offset:4096
    v_mul_f32 v12, v84, v244
    v_mfma_f32_16x16x32_bf16 v[100:103], a[236:239], a[84:87], v[100:103]
    s_addc_u32 s25, s25, 0
    ds_read_b128 a[200:203], v25 offset:4096
    v_mul_f32 v13, v85, v245
    v_mfma_f32_16x16x32_bf16 v[100:103], a[40:43], a[224:227], v[100:103]
    s_waitcnt vmcnt(10) lgkmcnt(3)
    ds_read_b128 a[128:131], v26 offset:4096
    v_mul_f32 v14, v86, v246
    v_mfma_f32_16x16x32_bf16 v[104:107], a[216:219], a[228:231], 0
    ds_read_b128 a[208:211], v27 offset:4096
    global_load_dwordx4 a[248:251], v24, s[24:25] offset:-4096 sc1
    v_mfma_f32_16x16x32_bf16 v[104:107], a[188:191], a[168:171], v[104:107]
    v_mul_f32 v15, v87, v247
    v_cvt_pk_bf16_f32 v10, v12, v13
    v_mfma_f32_16x16x32_bf16 v[104:107], a[196:199], a[244:247], v[104:107]
    v_cvt_pk_bf16_f32 v11, v14, v15
    v_mul_f32 v0, v88, v248
    v_mfma_f32_16x16x32_bf16 v[104:107], a[160:163], a[144:147], v[104:107]
    ds_write_b128 v24, v[8:11] offset:13312
    v_mfma_f32_16x16x32_bf16 v[108:111], a[212:215], a[228:231], 0
    global_load_dwordx4 a[116:119], v24, s[24:25] offset:-3072 sc1
    v_mul_f32 v1, v89, v249
    v_mfma_f32_16x16x32_bf16 v[108:111], a[92:95], a[168:171], v[108:111]
    v_mul_f32 v2, v90, v250
    v_mul_f32 v3, v91, v251
    v_mfma_f32_16x16x32_bf16 v[108:111], a[236:239], a[244:247], v[108:111]
    ds_read_b128 a[68:71], v24 offset:6144
    ds_read_b128 a[156:159], v25 offset:6144
    v_mfma_f32_16x16x32_bf16 v[108:111], a[40:43], a[144:147], v[108:111]
    s_waitcnt vmcnt(10) lgkmcnt(3)
    ds_read_b128 a[184:187], v26 offset:6144
    v_cvt_pk_bf16_f32 v0, v0, v1
    v_mfma_f32_16x16x32_bf16 v[112:115], a[216:219], a[172:175], 0
    ds_read_b128 a[96:99], v27 offset:6144
    global_load_dwordx4 a[204:207], v24, s[24:25] offset:-2048 sc1
    v_mfma_f32_16x16x32_bf16 v[112:115], a[188:191], a[200:203], v[112:115]
    v_cvt_pk_bf16_f32 v1, v2, v3
    v_mul_f32 v4, v92, v252
    v_mfma_f32_16x16x32_bf16 v[112:115], a[196:199], a[128:131], v[112:115]
    v_mul_f32 v5, v93, v253
    v_mul_f32 v6, v94, v254
    v_mfma_f32_16x16x32_bf16 v[112:115], a[160:163], a[208:211], v[112:115]
    v_mul_f32 v7, v95, v255
    v_cvt_pk_bf16_f32 v2, v4, v5
    v_mfma_f32_16x16x32_bf16 v[116:119], a[212:215], a[172:175], 0
    ds_read_b128 a[44:47], v24 offset:1024
    global_load_dwordx4 a[56:59], v24, s[24:25] offset:-1024 sc1
    v_mfma_f32_16x16x32_bf16 v[116:119], a[92:95], a[200:203], v[116:119]
    ds_read_b128 a[60:63], v25 offset:1024
    v_cvt_pk_bf16_f32 v3, v6, v7
    v_mfma_f32_16x16x32_bf16 v[116:119], a[236:239], a[128:131], v[116:119]
    ds_read_b128 a[72:75], v26 offset:1024
    v_mfma_f32_16x16x4_4b_bf16 v[240:255], a[34:35], a[38:39], v[240:255]
    ds_write_b128 v24, v[0:3] offset:15360
    v_mfma_f32_16x16x32_bf16 v[116:119], a[40:43], a[208:211], v[116:119]
    s_waitcnt vmcnt(9) lgkmcnt(4)
    global_load_dwordx4 a[64:67], v24, s[24:25] offset:0 sc1
    v_mfma_f32_16x16x32_bf16 v[120:123], a[216:219], a[68:71], 0
    ds_read_b128 a[80:83], v27 offset:1024
    ds_read_b128 a[112:115], v24 offset:3072
    v_mfma_f32_16x16x32_bf16 v[120:123], a[188:191], a[156:159], v[120:123]
    ds_read_b128 a[76:79], v25 offset:3072
    ds_read_b128 a[124:127], v26 offset:3072
    v_mfma_f32_16x16x32_bf16 v[120:123], a[196:199], a[184:187], v[120:123]
    global_load_dwordx4 a[104:107], v24, s[24:25] offset:1024 sc1
    v_mfma_f32_16x16x32_bf16 v[120:123], a[160:163], a[96:99], v[120:123]
    ds_read_b128 a[108:111], v27 offset:3072
    v_mfma_f32_16x16x32_bf16 v[124:127], a[212:215], a[68:71], 0
    ds_read_b128 a[48:51], v24 offset:5120
    v_mfma_f32_16x16x32_bf16 v[124:127], a[92:95], a[156:159], v[124:127]
    ds_read_b128 a[84:87], v25 offset:5120
    v_mfma_f32_16x16x32_bf16 v[124:127], a[236:239], a[184:187], v[124:127]
    v_mfma_f32_16x16x32_bf16 v[124:127], a[40:43], a[96:99], v[124:127]
    s_waitcnt vmcnt(9) lgkmcnt(5)
    global_load_dwordx4 a[224:227], v24, s[24:25] offset:2048 sc1
    v_mfma_f32_16x16x32_bf16 v[96:99], a[240:243], a[44:47], v[96:99]
    ds_read_b128 a[228:231], v26 offset:5120
    ds_read_b128 a[168:171], v27 offset:5120
    v_mfma_f32_16x16x32_bf16 v[96:99], a[120:123], a[60:63], v[96:99]
    v_mfma_f32_16x16x32_bf16 v[96:99], a[180:183], a[72:75], v[96:99]
    v_mfma_f32_16x16x32_bf16 v[96:99], a[136:139], a[80:83], v[96:99]
    global_load_dwordx4 a[244:247], v24, s[24:25] offset:3072 sc1
    v_mfma_f32_16x16x32_bf16 v[100:103], a[88:91], a[44:47], v[100:103]
    s_add_u32 s24, s24, 8192
    ds_read_b128 a[144:147], v24 offset:7168
    v_mfma_f32_16x16x32_bf16 v[100:103], a[220:223], a[60:63], v[100:103]
    s_addc_u32 s25, s25, 0
    ds_read_b128 a[172:175], v25 offset:7168
    v_mfma_f32_16x16x32_bf16 v[100:103], a[232:235], a[72:75], v[100:103]
    ds_read_b128 a[200:203], v26 offset:7168
    v_mfma_f32_16x16x32_bf16 v[100:103], a[176:179], a[80:83], v[100:103]
    global_load_dwordx4 a[128:131], v24, s[24:25] offset:-4096 sc1
    v_mfma_f32_16x16x32_bf16 v[104:107], a[240:243], a[112:115], v[104:107]
    s_waitcnt vmcnt(9) lgkmcnt(3)
    ds_read_b128 a[208:211], v27 offset:7168
    v_mfma_f32_16x16x32_bf16 v[104:107], a[120:123], a[76:79], v[104:107]
    v_mfma_f32_16x16x32_bf16 v[104:107], a[180:183], a[124:127], v[104:107]
    v_mfma_f32_16x16x32_bf16 v[104:107], a[136:139], a[108:111], v[104:107]
    global_load_dwordx4 a[216:219], v24, s[24:25] offset:-3072 sc1
    v_mfma_f32_16x16x32_bf16 v[108:111], a[88:91], a[112:115], v[108:111]
    ds_read_b128 a[188:191], v24 offset:8192
    v_mfma_f32_16x16x32_bf16 v[108:111], a[220:223], a[76:79], v[108:111]
    ds_read_b128 a[196:199], v25 offset:8192
    v_mfma_f32_16x16x32_bf16 v[108:111], a[232:235], a[124:127], v[108:111]
    ds_read_b128 a[160:163], v26 offset:8192
    v_mfma_f32_16x16x32_bf16 v[108:111], a[176:179], a[108:111], v[108:111]
    ds_read_b128 a[212:215], v27 offset:8192
    v_mfma_f32_16x16x32_bf16 v[112:115], a[240:243], a[48:51], v[112:115]
    global_load_dwordx4 a[68:71], v24, s[24:25] offset:-2048 sc1
    v_mfma_f32_16x16x32_bf16 v[112:115], a[120:123], a[84:87], v[112:115]
    v_mfma_f32_16x16x32_bf16 v[112:115], a[180:183], a[228:231], v[112:115]
    v_mfma_f32_16x16x32_bf16 v[112:115], a[136:139], a[168:171], v[112:115]
    v_mfma_f32_16x16x32_bf16 v[116:119], a[88:91], a[48:51], v[116:119]
    global_load_dwordx4 a[92:95], v24, s[24:25] offset:-1024 sc1
    v_mfma_f32_16x16x32_bf16 v[116:119], a[220:223], a[84:87], v[116:119]
    ds_read_b128 a[156:159], v24 offset:10240
    ds_read_b128 a[236:239], v25 offset:10240
    v_mfma_f32_16x16x32_bf16 v[116:119], a[232:235], a[228:231], v[116:119]
    ds_read_b128 a[184:187], v26 offset:10240
    v_mfma_f32_16x16x32_bf16 v[116:119], a[176:179], a[168:171], v[116:119]
    s_waitcnt vmcnt(9) lgkmcnt(3)
    ds_read_b128 a[40:43], v27 offset:10240
    v_mfma_f32_16x16x32_bf16 v[120:123], a[240:243], a[144:147], v[120:123]
    global_load_dwordx4 a[96:99], v24, s[24:25] offset:0 sc1
    v_mfma_f32_16x16x32_bf16 v[120:123], a[120:123], a[172:175], v[120:123]
    v_mfma_f32_16x16x32_bf16 v[120:123], a[180:183], a[200:203], v[120:123]
    v_mfma_f32_16x16x32_bf16 v[120:123], a[136:139], a[208:211], v[120:123]
    v_mfma_f32_16x16x32_bf16 v[124:127], a[88:91], a[144:147], v[124:127]
    global_load_dwordx4 a[44:47], v24, s[24:25] offset:1024 sc1
    v_mfma_f32_16x16x32_bf16 v[124:127], a[220:223], a[172:175], v[124:127]
    ds_read_b128 a[60:63], v24 offset:12288
    ds_read_b128 a[72:75], v25 offset:12288
    v_mfma_f32_16x16x32_bf16 v[124:127], a[232:235], a[200:203], v[124:127]
    ds_read_b128 a[80:83], v26 offset:12288
    v_mfma_f32_16x16x32_bf16 v[124:127], a[176:179], a[208:211], v[124:127]
    ds_read_b128 a[112:115], v27 offset:12288
    v_mfma_f32_16x16x32_bf16 v[96:99], a[148:151], a[188:191], v[96:99]
    v_mfma_f32_16x16x32_bf16 v[96:99], a[192:195], a[196:199], v[96:99]
    global_load_dwordx4 a[76:79], v24, s[24:25] offset:2048 sc1
    v_mfma_f32_16x16x32_bf16 v[96:99], a[164:167], a[160:163], v[96:99]
    v_mfma_f32_16x16x32_bf16 v[96:99], a[52:55], a[212:215], v[96:99]
    v_mfma_f32_16x16x32_bf16 v[100:103], a[152:155], a[188:191], v[100:103]
    ds_read_b128 a[124:127], v24 offset:14336
    v_mfma_f32_16x16x32_bf16 v[100:103], a[132:135], a[196:199], v[100:103]
    global_load_dwordx4 a[108:111], v24, s[24:25] offset:3072 sc1
    v_mfma_f32_16x16x32_bf16 v[100:103], a[100:103], a[160:163], v[100:103]
    s_add_u32 s24, s24, 8192
    ds_read_b128 a[48:51], v25 offset:14336
    ds_read_b128 a[84:87], v26 offset:14336
    v_mfma_f32_16x16x32_bf16 v[100:103], a[140:143], a[212:215], v[100:103]
    s_waitcnt vmcnt(8) lgkmcnt(3)
    s_addc_u32 s25, s25, 0
    v_mfma_f32_16x16x32_bf16 v[104:107], a[148:151], a[156:159], v[104:107]
    ds_read_b128 a[228:231], v27 offset:14336
    v_mfma_f32_16x16x32_bf16 v[104:107], a[192:195], a[236:239], v[104:107]
    global_load_dwordx4 a[168:171], v24, s[24:25] offset:-4096 sc1
    v_mfma_f32_16x16x32_bf16 v[104:107], a[164:167], a[184:187], v[104:107]
    v_mfma_f32_16x16x32_bf16 v[104:107], a[52:55], a[40:43], v[104:107]
    v_mfma_f32_16x16x32_bf16 v[108:111], a[152:155], a[156:159], v[108:111]
    ds_read_b128 a[240:243], v24 offset:9216
    v_mfma_f32_16x16x32_bf16 v[108:111], a[132:135], a[236:239], v[108:111]
    global_load_dwordx4 a[120:123], v24, s[24:25] offset:-3072 sc1
    v_mfma_f32_16x16x32_bf16 v[108:111], a[100:103], a[184:187], v[108:111]
    v_mfma_f32_16x16x32_bf16 v[108:111], a[140:143], a[40:43], v[108:111]
    v_mfma_f32_16x16x32_bf16 v[112:115], a[148:151], a[60:63], v[112:115]
    v_mfma_f32_16x16x32_bf16 v[112:115], a[192:195], a[72:75], v[112:115]
    v_mfma_f32_16x16x32_bf16 v[112:115], a[164:167], a[80:83], v[112:115]
    global_load_dwordx4 a[180:183], v24, s[24:25] offset:-2048 sc1
    v_mfma_f32_16x16x32_bf16 v[112:115], a[52:55], a[112:115], v[112:115]
    v_mfma_f32_16x16x32_bf16 v[116:119], a[152:155], a[60:63], v[116:119]
    s_barrier
    v_mfma_f32_16x16x32_bf16 v[116:119], a[132:135], a[72:75], v[116:119]
    ds_read_b128 a[136:139], v25 offset:9216
    ds_read_b128 a[88:91], v26 offset:9216
    v_mfma_f32_16x16x32_bf16 v[116:119], a[100:103], a[80:83], v[116:119]
    global_load_dwordx4 a[144:147], v24, s[24:25] offset:-1024 sc1
    v_mfma_f32_16x16x32_bf16 v[116:119], a[140:143], a[112:115], v[116:119]
    s_waitcnt vmcnt(9) lgkmcnt(2)
    ds_read_b128 a[220:223], v27 offset:9216
    ds_read_b128 a[172:175], v24 offset:11264
    v_mfma_f32_16x16x32_bf16 v[120:123], a[148:151], a[124:127], v[120:123]
    ds_read_b128 a[232:235], v25 offset:11264
    ds_read_b128 a[200:203], v26 offset:11264
    v_mfma_f32_16x16x32_bf16 v[120:123], a[192:195], a[48:51], v[120:123]
    ds_read_b128 a[176:179], v27 offset:11264
    v_mfma_f32_16x16x32_bf16 v[120:123], a[164:167], a[84:87], v[120:123]
    global_load_dwordx4 a[208:211], v24, s[24:25] offset:0 sc1
    v_mfma_f32_16x16x32_bf16 v[120:123], a[52:55], a[228:231], v[120:123]
    v_mfma_f32_16x16x32_bf16 v[124:127], a[152:155], a[124:127], v[124:127]
    ds_read_b128 a[188:191], v24 offset:13312
    v_mfma_f32_16x16x32_bf16 v[124:127], a[132:135], a[48:51], v[124:127]
    ds_read_b128 a[196:199], v25 offset:13312
    v_mfma_f32_16x16x32_bf16 v[124:127], a[100:103], a[84:87], v[124:127]
    global_load_dwordx4 a[160:163], v24, s[24:25] offset:1024 sc1
    v_mfma_f32_16x16x32_bf16 v[124:127], a[140:143], a[228:231], v[124:127]
    ds_read_b128 a[212:215], v26 offset:13312
    ds_read_b128 a[156:159], v27 offset:13312
    v_mfma_f32_16x16x32_bf16 v[96:99], a[248:251], a[240:243], v[96:99]
    s_waitcnt vmcnt(8) lgkmcnt(4)
    v_mfma_f32_16x16x32_bf16 v[96:99], a[116:119], a[136:139], v[96:99]
    v_mfma_f32_16x16x32_bf16 v[96:99], a[204:207], a[88:91], v[96:99]
    v_mfma_f32_16x16x32_bf16 v[96:99], a[56:59], a[220:223], v[96:99]
    global_load_dwordx4 a[236:239], v24, s[24:25] offset:2048 sc1
    s_nop 0
    v_mfma_f32_16x16x32_bf16 v[100:103], a[64:67], a[240:243], v[100:103]
    s_nop 1
    v_mfma_f32_16x16x32_bf16 v[100:103], a[104:107], a[136:139], v[100:103]
    s_nop 1
    v_mfma_f32_16x16x32_bf16 v[100:103], a[224:227], a[88:91], v[100:103]
    v_cvt_pk_bf16_f32 v96, v96, v97
    v_cvt_pk_bf16_f32 v97, v98, v99
    v_mfma_f32_16x16x32_bf16 v[100:103], a[244:247], a[220:223], v[100:103]
    global_load_dwordx4 a[184:187], v24, s[24:25] offset:3072 sc1
    s_nop 0
    v_mfma_f32_16x16x32_bf16 v[104:107], a[248:251], a[172:175], v[104:107]
    s_add_u32 s24, s24, 8192
    s_nop 1
    v_mfma_f32_16x16x32_bf16 v[104:107], a[116:119], a[232:235], v[104:107]
    s_addc_u32 s25, s25, 0
    v_cvt_pk_bf16_f32 v98, v100, v101
    v_cvt_pk_bf16_f32 v99, v102, v103
    v_mfma_f32_16x16x32_bf16 v[104:107], a[204:207], a[200:203], v[104:107]
    ds_write_b128 v24, v[96:99] offset:16384
    v_mfma_f32_16x16x32_bf16 v[104:107], a[56:59], a[176:179], v[104:107]
    global_load_dwordx4 a[40:43], v24, s[24:25] offset:-4096 sc1
    s_nop 0
    v_mfma_f32_16x16x32_bf16 v[108:111], a[64:67], a[172:175], v[108:111]
    s_nop 1
    v_mfma_f32_16x16x32_bf16 v[108:111], a[104:107], a[232:235], v[108:111]
    ds_read_b128 a[60:63], v24 offset:15360
    s_nop 0
    v_mfma_f32_16x16x32_bf16 v[108:111], a[224:227], a[200:203], v[108:111]
    ds_read_b128 a[72:75], v25 offset:15360
L_LAND3_0:
    s_cbranch_vccnz L_RET
    v_cvt_pk_bf16_f32 v104, v104, v105
    v_mfma_f32_16x16x32_bf16 v[108:111], a[244:247], a[176:179], v[108:111]
    s_waitcnt vmcnt(8) lgkmcnt(3)
    ds_read_b128 a[80:83], v26 offset:15360
    global_load_dwordx4 a[112:115], v24, s[24:25] offset:-3072 sc1
    v_mfma_f32_16x16x32_bf16 v[112:115], a[248:251], a[188:191], v[112:115]
    ds_read_b128 a[148:151], v27 offset:15360
    v_cvt_pk_bf16_f32 v105, v106, v107
    v_mfma_f32_16x16x32_bf16 v[112:115], a[116:119], a[196:199], v[112:115]
    ds_read_b128 v[16:19], v24 offset:28672
    v_cvt_pk_bf16_f32 v106, v108, v109
    v_mfma_f32_16x16x32_bf16 v[112:115], a[204:207], a[212:215], v[112:115]
    ds_read_b128 v[20:23], v24 offset:29696
    v_cvt_pk_bf16_f32 v107, v110, v111
    v_mfma_f32_16x16x32_bf16 v[112:115], a[56:59], a[156:159], v[112:115]
    ds_write_b128 v24, v[104:107] offset:17408
    v_mfma_f32_16x16x32_bf16 v[116:119], a[64:67], a[188:191], v[116:119]
    global_load_dwordx4 a[192:195], v24, s[24:25] offset:-2048 sc1
    s_nop 0
    v_mfma_f32_16x16x32_bf16 v[116:119], a[104:107], a[196:199], v[116:119]
    s_nop 1
    v_mfma_f32_16x16x32_bf16 v[116:119], a[224:227], a[212:215], v[116:119]
    s_waitcnt vmcnt(8) lgkmcnt(0)
    s_barrier
    v_mfma_f32_16x16x32_bf16 v[116:119], a[244:247], a[156:159], v[116:119]
    ds_read_b128 v[100:103], v25 offset:16384
    global_load_dwordx4 a[164:167], v24, s[24:25] offset:-1024 sc1
    v_mfma_f32_16x16x32_bf16 v[120:123], a[248:251], a[60:63], v[120:123]
    ds_read_b128 a[52:55], v26 offset:16384
    v_cvt_pk_bf16_f32 v112, v112, v113
    v_mfma_f32_16x16x32_bf16 v[120:123], a[116:119], a[72:75], v[120:123]
    ds_read_b128 a[152:155], v27 offset:16384
    v_cvt_pk_bf16_f32 v113, v114, v115
    v_mfma_f32_16x16x32_bf16 v[120:123], a[204:207], a[80:83], v[120:123]
    ds_read_b128 v[8:11], v24 offset:34816
    v_cvt_pk_bf16_f32 v114, v116, v117
    v_mfma_f32_16x16x32_bf16 v[120:123], a[56:59], a[148:151], v[120:123]
    ds_read_b128 v[12:15], v24 offset:35840
    global_load_dwordx4 a[124:127], v24, s[24:25] offset:0 sc1
    v_mfma_f32_16x16x32_bf16 v[124:127], a[64:67], a[60:63], v[124:127]
    v_cvt_pk_bf16_f32 v115, v118, v119
    s_nop 0
    v_mfma_f32_16x16x32_bf16 v[124:127], a[104:107], a[72:75], v[124:127]
    ds_write_b128 v24, v[112:115] offset:18432
    v_mfma_f32_16x16x32_bf16 v[124:127], a[224:227], a[80:83], v[124:127]
    global_load_dwordx4 a[132:135], v24, s[24:25] offset:1024 sc1
    v_cvt_pk_bf16_f32 v120, v120, v121
    v_mfma_f32_16x16x32_bf16 v[124:127], a[244:247], a[148:151], v[124:127]
    v_cvt_pk_bf16_f32 v121, v122, v123
    s_nop 0
    v_mfma_f32_16x16x32_bf16 v[128:131], a[128:131], v[96:99], v[128:131]
    s_waitcnt vmcnt(9) lgkmcnt(3)
    ds_read_b128 v[0:3], v24 offset:30720
    s_nop 0
    v_mfma_f32_16x16x32_bf16 v[128:131], a[216:219], v[100:103], v[128:131]
    ds_read_b128 v[4:7], v24 offset:31744
    v_cvt_pk_bf16_f32 v122, v124, v125
    v_mfma_f32_16x16x32_bf16 v[128:131], a[68:71], a[52:55], v[128:131]
    global_load_dwordx4 a[48:51], v24, s[24:25] offset:2048 sc1
    v_cvt_pk_bf16_f32 v123, v126, v127
    v_mfma_f32_16x16x32_bf16 v[128:131], a[92:95], a[152:155], v[128:131]
    ds_write_b128 v24, v[120:123] offset:19456
    v_mfma_f32_16x16x32_bf16 v[132:135], a[96:99], v[96:99], v[132:135]
    v_mfma_f32_16x16x32_bf16 v[132:135], a[44:47], v[100:103], v[132:135]
    v_mfma_f32_16x16x32_bf16 v[132:135], a[76:79], a[52:55], v[132:135]
    global_load_dwordx4 a[100:103], v24, s[24:25] offset:3072 sc1
    v_mfma_f32_16x16x32_bf16 v[132:135], a[108:111], a[152:155], v[132:135]
    s_add_u32 s24, s24, 8192
    ds_read_b128 v[108:111], v25 offset:17408
    v_mul_f32 v128, v16, v128
    v_mfma_f32_16x16x32_bf16 v[160:163], a[168:171], v[96:99], v[160:163]
    s_addc_u32 s25, s25, 0
    ds_read_b128 a[84:87], v26 offset:17408
    v_mul_f32 v129, v17, v129
    v_mfma_f32_16x16x32_bf16 v[160:163], a[120:123], v[100:103], v[160:163]
    ds_read_b128 a[140:143], v27 offset:17408
    v_mul_f32 v130, v18, v130
    v_mfma_f32_16x16x32_bf16 v[160:163], a[180:183], a[52:55], v[160:163]
    global_load_dwordx4 a[228:231], v24, s[24:25] offset:-4096 sc1
    v_mul_f32 v131, v19, v131
    v_mfma_f32_16x16x32_bf16 v[160:163], a[144:147], a[152:155], v[160:163]
    v_cvt_pk_bf16_f32 v128, v128, v129
    v_cvt_pk_bf16_f32 v129, v130, v131
    v_mfma_f32_16x16x32_bf16 v[164:167], a[208:211], v[96:99], v[164:167]
    s_waitcnt vmcnt(9) lgkmcnt(3)
    v_mul_f32 v132, v20, v132
    v_mul_f32 v133, v21, v133
    v_mfma_f32_16x16x32_bf16 v[164:167], a[160:163], v[100:103], v[164:167]
    v_mul_f32 v134, v22, v134
    v_mul_f32 v135, v23, v135
    v_mfma_f32_16x16x32_bf16 v[164:167], a[236:239], a[52:55], v[164:167]
    ds_read_b128 v[16:19], v24 offset:36864
    global_load_dwordx4 a[240:243], v24, s[24:25] offset:-3072 sc1
    v_mfma_f32_16x16x32_bf16 v[164:167], a[184:187], a[152:155], v[164:167]
    ds_read_b128 v[20:23], v24 offset:37888
    v_cvt_pk_bf16_f32 v130, v132, v133
    v_mfma_f32_16x16x32_bf16 v[136:139], a[128:131], v[104:107], v[136:139]
    s_waitcnt vmcnt(9) lgkmcnt(2)
    v_cvt_pk_bf16_f32 v131, v134, v135
    v_mul_f32 v160, v8, v160
    v_mfma_f32_16x16x32_bf16 v[136:139], a[216:219], v[108:111], v[136:139]
    ds_write_b128 v34, v[128:131] offset:0
    v_mfma_f32_16x16x32_bf16 v[136:139], a[68:71], a[84:87], v[136:139]
    global_load_dwordx4 a[136:139], v24, s[24:25] offset:-2048 sc1
    v_mul_f32 v161, v9, v161
    v_mfma_f32_16x16x32_bf16 v[136:139], a[92:95], a[140:143], v[136:139]
    v_mul_f32 v162, v10, v162
    v_mul_f32 v163, v11, v163
    v_mfma_f32_16x16x32_bf16 v[140:143], a[96:99], v[104:107], v[140:143]
    v_cvt_pk_bf16_f32 v160, v160, v161
    v_cvt_pk_bf16_f32 v161, v162, v163
    v_mfma_f32_16x16x32_bf16 v[140:143], a[44:47], v[108:111], v[140:143]
    v_mul_f32 v164, v12, v164
    v_mul_f32 v165, v13, v165
    v_mfma_f32_16x16x32_bf16 v[140:143], a[76:79], a[84:87], v[140:143]
    s_barrier
    v_mul_f32 v166, v14, v166
    v_mfma_f32_16x16x32_bf16 v[140:143], a[108:111], a[140:143], v[140:143]
    ds_read_b128 v[116:119], v25 offset:18432
    global_load_dwordx4 a[88:91], v24, s[24:25] offset:-1024 sc1
    v_mfma_f32_16x16x32_bf16 v[168:171], a[168:171], v[104:107], v[168:171]
    ds_read_b128 a[220:223], v26 offset:18432
    v_mul_f32 v167, v15, v167
    v_mfma_f32_16x16x32_bf16 v[168:171], a[120:123], v[108:111], v[168:171]
    ds_read_b128 a[172:175], v27 offset:18432
    v_cvt_pk_bf16_f32 v162, v164, v165
    v_mfma_f32_16x16x32_bf16 v[168:171], a[180:183], a[84:87], v[168:171]
    ds_read_b128 v[8:11], v24 offset:32768
    global_load_dwordx4 a[232:235], v24, s[24:25] offset:0 sc1
    v_mfma_f32_16x16x32_bf16 v[168:171], a[144:147], a[140:143], v[168:171]
    ds_read_b128 v[12:15], v24 offset:33792
    v_cvt_pk_bf16_f32 v163, v166, v167
    v_mfma_f32_16x16x32_bf16 v[172:175], a[208:211], v[104:107], v[172:175]
    ds_write_b128 v35, v[160:163] offset:0
    v_mfma_f32_16x16x32_bf16 v[172:175], a[160:163], v[108:111], v[172:175]
    v_mul_f32 v136, v0, v136
    v_mul_f32 v137, v1, v137
    v_mfma_f32_16x16x32_bf16 v[172:175], a[236:239], a[84:87], v[172:175]
    global_load_dwordx4 a[200:203], v24, s[24:25] offset:1024 sc1
    v_mul_f32 v138, v2, v138
    v_mfma_f32_16x16x32_bf16 v[172:175], a[184:187], a[140:143], v[172:175]
    ds_read_b128 a[176:179], v36 offset:0
    v_mul_f32 v139, v3, v139
    v_mfma_f32_16x16x32_bf16 v[144:147], a[128:131], v[112:115], v[144:147]
    s_waitcnt vmcnt(9) lgkmcnt(4)
    ds_read_b128 a[188:191], v36 offset:1024
    v_cvt_pk_bf16_f32 v136, v136, v137
    v_mfma_f32_16x16x32_bf16 v[144:147], a[216:219], v[116:119], v[144:147]
    v_cvt_pk_bf16_f32 v137, v138, v139
    v_mul_f32 v140, v4, v140
    v_mfma_f32_16x16x32_bf16 v[144:147], a[68:71], a[220:223], v[144:147]
    global_load_dwordx4 a[196:199], v24, s[24:25] offset:2048 sc1
    v_mul_f32 v141, v5, v141
    v_mfma_f32_16x16x32_bf16 v[144:147], a[92:95], a[172:175], v[144:147]
    v_mul_f32 v142, v6, v142
    v_mul_f32 v143, v7, v143
    v_mfma_f32_16x16x32_bf16 v[148:151], a[96:99], v[112:115], v[148:151]
    ds_read_b128 v[0:3], v24 offset:38912
    v_cvt_pk_bf16_f32 v138, v140, v141
    v_mfma_f32_16x16x32_bf16 v[148:151], a[44:47], v[116:119], v[148:151]
    ds_read_b128 v[4:7], v24 offset:39936
    v_cvt_pk_bf16_f32 v139, v142, v143
    v_mfma_f32_16x16x32_bf16 v[148:151], a[76:79], a[220:223], v[148:151]
    ds_write_b128 v34, v[136:139] offset:2048
    v_mfma_f32_16x16x32_bf16 v[148:151], a[108:111], a[172:175], v[148:151]
    global_load_dwordx4 a[212:215], v24, s[24:25] offset:3072 sc1
    v_mul_f32 v168, v16, v168
    v_mfma_f32_16x16x32_bf16 v[176:179], a[168:171], v[112:115], v[176:179]
    v_mul_f32 v169, v17, v169
    v_mul_f32 v170, v18, v170
    v_mfma_f32_16x16x32_bf16 v[176:179], a[120:123], v[116:119], v[176:179]
    ds_read_b128 v[124:127], v25 offset:19456
    ds_read_b128 a[156:159], v26 offset:19456
    v_mfma_f32_16x16x32_bf16 v[176:179], a[180:183], a[220:223], v[176:179]
    s_waitcnt vmcnt(8) lgkmcnt(5)
    global_store_dwordx4 v28, a[176:179], s[40:41] offset:0 nt
    v_mul_f32 v171, v19, v171
    v_cvt_pk_bf16_f32 v168, v168, v169
    v_mfma_f32_16x16x32_bf16 v[176:179], a[144:147], a[172:175], v[176:179]
    ds_read_b128 a[248:251], v27 offset:19456
    v_cvt_pk_bf16_f32 v169, v170, v171
    v_mfma_f32_16x16x32_bf16 v[180:183], a[208:211], v[112:115], v[180:183]
    v_mul_f32 v172, v20, v172
    v_mul_f32 v173, v21, v173
    v_mfma_f32_16x16x32_bf16 v[180:183], a[160:163], v[116:119], v[180:183]
    global_store_dwordx4 v37, a[188:191], s[40:41] offset:0 nt
    v_mul_f32 v174, v22, v174
    v_mul_f32 v175, v23, v175
    v_mfma_f32_16x16x32_bf16 v[180:183], a[236:239], a[220:223], v[180:183]
    v_cvt_pk_bf16_f32 v170, v172, v173
    v_cvt_pk_bf16_f32 v171, v174, v175
    v_mfma_f32_16x16x32_bf16 v[180:183], a[184:187], a[172:175], v[180:183]
    ds_write_b128 v35, v[168:171] offset:2048
    v_mfma_f32_16x16x32_bf16 v[152:155], a[128:131], v[120:123], v[152:155]
    s_waitcnt vmcnt(9) lgkmcnt(2)
    v_mul_f32 v144, v8, v144
    v_mul_f32 v145, v9, v145
    v_mfma_f32_16x16x32_bf16 v[152:155], a[216:219], v[124:127], v[152:155]
    v_mul_f32 v146, v10, v146
    v_mul_f32 v147, v11, v147
    v_mfma_f32_16x16x32_bf16 v[152:155], a[68:71], a[156:159], v[152:155]
    s_waitcnt vmcnt(8) lgkmcnt(1)
    ds_read_b128 a[116:119], v36 offset:2048
    v_cvt_pk_bf16_f32 v144, v144, v145
    v_mfma_f32_16x16x32_bf16 v[152:155], a[92:95], a[248:251], v[152:155]
    ds_read_b128 a[204:207], v36 offset:3072
    v_cvt_pk_bf16_f32 v145, v146, v147
    v_mfma_f32_16x16x32_bf16 v[156:159], a[96:99], v[120:123], v[156:159]
    v_mul_f32 v148, v12, v148
    v_mul_f32 v149, v13, v149
    v_mfma_f32_16x16x32_bf16 v[156:159], a[44:47], v[124:127], v[156:159]
    v_mul_f32 v150, v14, v150
    v_mul_f32 v151, v15, v151
    v_mfma_f32_16x16x32_bf16 v[156:159], a[76:79], a[156:159], v[156:159]
    v_cvt_pk_bf16_f32 v146, v148, v149
    v_cvt_pk_bf16_f32 v147, v150, v151
    v_mfma_f32_16x16x32_bf16 v[156:159], a[108:111], a[248:251], v[156:159]
    ds_write_b128 v34, v[144:147] offset:4096
    v_mfma_f32_16x16x32_bf16 v[184:187], a[168:171], v[120:123], v[184:187]
    s_waitcnt vmcnt(7) lgkmcnt(2)
    global_store_dwordx4 v28, a[116:119], s[42:43] offset:0 nt
    v_mul_f32 v176, v0, v176
    v_mul_f32 v177, v1, v177
    v_mfma_f32_16x16x32_bf16 v[184:187], a[120:123], v[124:127], v[184:187]
    s_waitcnt lgkmcnt(1)
    global_store_dwordx4 v37, a[204:207], s[42:43] offset:0 nt
    v_mul_f32 v178, v2, v178
    v_mul_f32 v179, v3, v179
    v_mfma_f32_16x16x32_bf16 v[184:187], a[180:183], a[156:159], v[184:187]
    v_cvt_pk_bf16_f32 v176, v176, v177
    v_cvt_pk_bf16_f32 v177, v178, v179
    v_mfma_f32_16x16x32_bf16 v[184:187], a[144:147], a[248:251], v[184:187]
    v_mul_f32 v180, v4, v180
    v_mul_f32 v181, v5, v181
    v_mfma_f32_16x16x32_bf16 v[188:191], a[208:211], v[120:123], v[188:191]
    v_mul_f32 v182, v6, v182
    v_mul_f32 v183, v7, v183
    v_mfma_f32_16x16x32_bf16 v[188:191], a[160:163], v[124:127], v[188:191]
    v_cvt_pk_bf16_f32 v178, v180, v181
    v_cvt_pk_bf16_f32 v179, v182, v183
    v_mfma_f32_16x16x32_bf16 v[188:191], a[236:239], a[156:159], v[188:191]
    ds_write_b128 v35, v[176:179] offset:4096
    v_mfma_f32_16x16x32_bf16 v[188:191], a[184:187], a[248:251], v[188:191]
    v_accvgpr_read_b32 v16, a0
    v_accvgpr_read_b32 v17, a1
    v_mfma_f32_16x16x32_bf16 v[192:195], a[40:43], v[96:99], v[192:195]
    v_accvgpr_read_b32 v18, a2
    v_accvgpr_read_b32 v19, a3
    v_mfma_f32_16x16x32_bf16 v[192:195], a[112:115], v[100:103], v[192:195]
    ds_read_b128 a[56:59], v36 offset:4096
    v_accvgpr_read_b32 v20, a4
    v_mfma_f32_16x16x32_bf16 v[192:195], a[192:195], a[52:55], v[192:195]
    ds_read_b128 a[64:67], v36 offset:5120
    v_accvgpr_read_b32 v21, a5
    v_mfma_f32_16x16x32_bf16 v[192:195], a[164:167], a[152:155], v[192:195]
    v_accvgpr_read_b32 v22, a6
    v_accvgpr_read_b32 v23, a7
    v_mfma_f32_16x16x32_bf16 v[196:199], a[124:127], v[96:99], v[196:199]
    v_mul_f32 v152, v16, v152
    v_mul_f32 v153, v17, v153
    v_mfma_f32_16x16x32_bf16 v[196:199], a[132:135], v[100:103], v[196:199]
    v_mul_f32 v154, v18, v154
    v_mul_f32 v155, v19, v155
    v_mfma_f32_16x16x32_bf16 v[196:199], a[48:51], a[52:55], v[196:199]
    v_cvt_pk_bf16_f32 v152, v152, v153
    v_cvt_pk_bf16_f32 v153, v154, v155
    v_mfma_f32_16x16x32_bf16 v[196:199], a[100:103], a[152:155], v[196:199]
    s_waitcnt vmcnt(5) lgkmcnt(1)
    global_store_dwordx4 v28, a[56:59], s[44:45] offset:0 nt
    v_mul_f32 v156, v20, v156
    v_mul_f32 v157, v21, v157
    v_mfma_f32_16x16x32_bf16 v[224:227], a[228:231], v[96:99], v[224:227]
    s_waitcnt lgkmcnt(0)
    global_store_dwordx4 v37, a[64:67], s[44:45] offset:0 nt
    v_mul_f32 v158, v22, v158
    v_mul_f32 v159, v23, v159
    v_mfma_f32_16x16x32_bf16 v[224:227], a[240:243], v[100:103], v[224:227]
    v_cvt_pk_bf16_f32 v154, v156, v157
    v_cvt_pk_bf16_f32 v155, v158, v159
    v_mfma_f32_16x16x32_bf16 v[224:227], a[136:139], a[52:55], v[224:227]
    ds_write_b128 v34, v[152:155] offset:6144
    v_mfma_f32_16x16x32_bf16 v[224:227], a[88:91], a[152:155], v[224:227]
    v_accvgpr_read_b32 v8, a8
    v_accvgpr_read_b32 v9, a9
    v_mfma_f32_16x16x32_bf16 v[228:231], a[232:235], v[96:99], v[228:231]
    v_accvgpr_read_b32 v10, a10
    v_accvgpr_read_b32 v11, a11
    v_mfma_f32_16x16x32_bf16 v[228:231], a[200:203], v[100:103], v[228:231]
    v_accvgpr_read_b32 v12, a12
    v_accvgpr_read_b32 v13, a13
    v_mfma_f32_16x16x32_bf16 v[228:231], a[196:199], a[52:55], v[228:231]
    s_waitcnt vmcnt(5)
    v_accvgpr_read_b32 v14, a14
    v_accvgpr_read_b32 v15, a15
    v_mfma_f32_16x16x32_bf16 v[228:231], a[212:215], a[152:155], v[228:231]
    v_mul_f32 v184, v8, v184
    v_mul_f32 v185, v9, v185
    v_mfma_f32_16x16x32_bf16 v[200:203], a[40:43], v[104:107], v[200:203]
    v_mul_f32 v186, v10, v186
    v_mul_f32 v187, v11, v187
    v_mfma_f32_16x16x32_bf16 v[200:203], a[112:115], v[108:111], v[200:203]
    v_cvt_pk_bf16_f32 v184, v184, v185
    v_cvt_pk_bf16_f32 v185, v186, v187
    v_mfma_f32_16x16x32_bf16 v[200:203], a[192:195], a[84:87], v[200:203]
    v_mul_f32 v188, v12, v188
    v_mul_f32 v189, v13, v189
    v_mfma_f32_16x16x32_bf16 v[200:203], a[164:167], a[140:143], v[200:203]
    v_mul_f32 v190, v14, v190
    v_mul_f32 v191, v15, v191
    v_mfma_f32_16x16x32_bf16 v[204:207], a[124:127], v[104:107], v[204:207]
    v_cvt_pk_bf16_f32 v186, v188, v189
    v_cvt_pk_bf16_f32 v187, v190, v191
    v_mfma_f32_16x16x32_bf16 v[204:207], a[132:135], v[108:111], v[204:207]
    ds_write_b128 v35, v[184:187] offset:6144
    v_mfma_f32_16x16x32_bf16 v[204:207], a[48:51], a[84:87], v[204:207]
    v_accvgpr_read_b32 v0, a16
    v_accvgpr_read_b32 v1, a17
    v_mfma_f32_16x16x32_bf16 v[204:207], a[100:103], a[140:143], v[204:207]
    v_accvgpr_read_b32 v2, a18
    v_accvgpr_read_b32 v3, a19
    v_mfma_f32_16x16x32_bf16 v[232:235], a[228:231], v[104:107], v[232:235]
    ds_read_b128 a[60:63], v36 offset:6144
    v_accvgpr_read_b32 v4, a20
    v_mfma_f32_16x16x32_bf16 v[232:235], a[240:243], v[108:111], v[232:235]
    ds_read_b128 a[104:107], v36 offset:7168
    v_accvgpr_read_b32 v5, a21
    v_mfma_f32_16x16x32_bf16 v[232:235], a[136:139], a[84:87], v[232:235]
    v_accvgpr_read_b32 v6, a22
    v_accvgpr_read_b32 v7, a23
    v_mfma_f32_16x16x32_bf16 v[232:235], a[88:91], a[140:143], v[232:235]
    v_mul_f32 v192, v0, v192
    v_mul_f32 v193, v1, v193
    v_mfma_f32_16x16x32_bf16 v[236:239], a[232:235], v[104:107], v[236:239]
    v_mul_f32 v194, v2, v194
    v_mul_f32 v195, v3, v195
    v_mfma_f32_16x16x32_bf16 v[236:239], a[200:203], v[108:111], v[236:239]
    v_cvt_pk_bf16_f32 v192, v192, v193
    v_cvt_pk_bf16_f32 v193, v194, v195
    v_mfma_f32_16x16x32_bf16 v[236:239], a[196:199], a[84:87], v[236:239]
    s_waitcnt vmcnt(2) lgkmcnt(1)
    global_store_dwordx4 v28, a[60:63], s[46:47] offset:0 nt
    v_mul_f32 v196, v4, v196
    v_mul_f32 v197, v5, v197
    v_mfma_f32_16x16x32_bf16 v[236:239], a[212:215], a[140:143], v[236:239]
    s_waitcnt lgkmcnt(0)
    global_store_dwordx4 v37, a[104:107], s[46:47] offset:0 nt
    v_mul_f32 v198, v6, v198
    v_mul_f32 v199, v7, v199
    v_mfma_f32_16x16x32_bf16 v[208:211], a[40:43], v[112:115], v[208:211]
    v_cvt_pk_bf16_f32 v194, v196, v197
    v_cvt_pk_bf16_f32 v195, v198, v199
    v_mfma_f32_16x16x32_bf16 v[208:211], a[112:115], v[116:119], v[208:211]
    ds_write_b128 v34, v[192:195] offset:8192
    v_mfma_f32_16x16x32_bf16 v[208:211], a[192:195], a[220:223], v[208:211]
    v_mul_f32 v224, v64, v224
    v_mul_f32 v225, v65, v225
    v_mfma_f32_16x16x32_bf16 v[208:211], a[164:167], a[172:175], v[208:211]
    v_mul_f32 v226, v66, v226
    v_mul_f32 v227, v67, v227
    v_mfma_f32_16x16x32_bf16 v[212:215], a[124:127], v[112:115], v[212:215]
    v_cvt_pk_bf16_f32 v224, v224, v225
    v_cvt_pk_bf16_f32 v225, v226, v227
    v_mfma_f32_16x16x32_bf16 v[212:215], a[132:135], v[116:119], v[212:215]
    v_mul_f32 v228, v68, v228
    v_mul_f32 v229, v69, v229
    v_mfma_f32_16x16x32_bf16 v[212:215], a[48:51], a[220:223], v[212:215]
    v_mul_f32 v230, v70, v230
    v_mul_f32 v231, v71, v231
    v_mfma_f32_16x16x32_bf16 v[212:215], a[100:103], a[172:175], v[212:215]
    v_cvt_pk_bf16_f32 v226, v228, v229
    v_cvt_pk_bf16_f32 v227, v230, v231
    v_mfma_f32_16x16x32_bf16 v[240:243], a[228:231], v[112:115], v[240:243]
    ds_write_b128 v35, v[224:227] offset:8192
    v_mfma_f32_16x16x32_bf16 v[240:243], a[240:243], v[116:119], v[240:243]
    v_mul_f32 v200, v40, v200
    v_mul_f32 v201, v41, v201
    v_mfma_f32_16x16x32_bf16 v[240:243], a[136:139], a[220:223], v[240:243]
    v_mul_f32 v202, v42, v202
    v_mul_f32 v203, v43, v203
    v_mfma_f32_16x16x32_bf16 v[240:243], a[88:91], a[172:175], v[240:243]
    ds_read_b128 a[72:75], v36 offset:8192
    v_cvt_pk_bf16_f32 v200, v200, v201
    v_mfma_f32_16x16x32_bf16 v[244:247], a[232:235], v[112:115], v[244:247]
    ds_read_b128 a[224:227], v36 offset:9216
    v_cvt_pk_bf16_f32 v201, v202, v203
    v_mfma_f32_16x16x32_bf16 v[244:247], a[200:203], v[116:119], v[244:247]
    v_mul_f32 v204, v44, v204
    v_mul_f32 v205, v45, v205
    v_mfma_f32_16x16x32_bf16 v[244:247], a[196:199], a[220:223], v[244:247]
    v_mul_f32 v206, v46, v206
    v_mul_f32 v207, v47, v207
    v_mfma_f32_16x16x32_bf16 v[244:247], a[212:215], a[172:175], v[244:247]
    v_cvt_pk_bf16_f32 v202, v204, v205
    v_cvt_pk_bf16_f32 v203, v206, v207
    v_mfma_f32_16x16x32_bf16 v[216:219], a[40:43], v[120:123], v[216:219]
    ds_write_b128 v34, v[200:203] offset:10240
    v_mfma_f32_16x16x32_bf16 v[216:219], a[112:115], v[124:127], v[216:219]
    s_waitcnt vmcnt(2) lgkmcnt(2)
    global_store_dwordx4 v28, a[72:75], s[40:41] offset:128 nt
    v_mul_f32 v232, v72, v232
    v_mul_f32 v233, v73, v233
    v_mfma_f32_16x16x32_bf16 v[216:219], a[192:195], a[156:159], v[216:219]
    s_waitcnt lgkmcnt(1)
    global_store_dwordx4 v37, a[224:227], s[40:41] offset:128 nt
    v_mul_f32 v234, v74, v234
    v_mul_f32 v235, v75, v235
    v_mfma_f32_16x16x32_bf16 v[216:219], a[164:167], a[248:251], v[216:219]
    v_cvt_pk_bf16_f32 v232, v232, v233
    v_cvt_pk_bf16_f32 v233, v234, v235
    v_mfma_f32_16x16x32_bf16 v[220:223], a[124:127], v[120:123], v[220:223]
    v_mul_f32 v236, v76, v236
    v_mul_f32 v237, v77, v237
    v_mfma_f32_16x16x32_bf16 v[220:223], a[132:135], v[124:127], v[220:223]
    v_mul_f32 v238, v78, v238
    v_mul_f32 v239, v79, v239
    v_mfma_f32_16x16x32_bf16 v[220:223], a[48:51], a[156:159], v[220:223]
    v_cvt_pk_bf16_f32 v234, v236, v237
    v_cvt_pk_bf16_f32 v235, v238, v239
    v_mfma_f32_16x16x32_bf16 v[220:223], a[100:103], a[248:251], v[220:223]
    ds_write_b128 v35, v[232:235] offset:10240
    v_mfma_f32_16x16x32_bf16 v[248:251], a[228:231], v[120:123], v[248:251]
    v_mul_f32 v208, v48, v208
    v_mul_f32 v209, v49, v209
    v_mfma_f32_16x16x32_bf16 v[248:251], a[240:243], v[124:127], v[248:251]
    v_mul_f32 v210, v50, v210
    v_mul_f32 v211, v51, v211
    v_mfma_f32_16x16x32_bf16 v[248:251], a[136:139], a[156:159], v[248:251]
    ds_read_b128 a[80:83], v36 offset:10240
    v_cvt_pk_bf16_f32 v208, v208, v209
    v_mfma_f32_16x16x32_bf16 v[248:251], a[88:91], a[248:251], v[248:251]
    ds_read_b128 a[244:247], v36 offset:11264
    v_cvt_pk_bf16_f32 v209, v210, v211
    v_mfma_f32_16x16x32_bf16 v[252:255], a[232:235], v[120:123], v[252:255]
    v_mul_f32 v212, v52, v212
    v_mul_f32 v213, v53, v213
    v_mfma_f32_16x16x32_bf16 v[252:255], a[200:203], v[124:127], v[252:255]
    v_mul_f32 v214, v54, v214
    v_mul_f32 v215, v55, v215
    v_mfma_f32_16x16x32_bf16 v[252:255], a[196:199], a[156:159], v[252:255]
    v_cvt_pk_bf16_f32 v210, v212, v213
    v_cvt_pk_bf16_f32 v211, v214, v215
    v_mfma_f32_16x16x32_bf16 v[252:255], a[212:215], a[248:251], v[252:255]
    ds_write_b128 v34, v[208:211] offset:12288
    v_mul_f32 v240, v80, v240
    v_mul_f32 v241, v81, v241
    v_mul_f32 v242, v82, v242
    v_mul_f32 v243, v83, v243
    v_cvt_pk_bf16_f32 v240, v240, v241
    v_cvt_pk_bf16_f32 v241, v242, v243
    v_mul_f32 v244, v84, v244
    v_mul_f32 v245, v85, v245
    v_mul_f32 v246, v86, v246
    v_mul_f32 v247, v87, v247
    v_cvt_pk_bf16_f32 v242, v244, v245
    v_cvt_pk_bf16_f32 v243, v246, v247
    ds_write_b128 v35, v[240:243] offset:12288
    ds_read_b128 a[148:151], v36 offset:12288
    ds_read_b128 a[128:131], v36 offset:13312
    v_mul_f32 v216, v56, v216
    v_mul_f32 v217, v57, v217
    v_mul_f32 v218, v58, v218
    v_mul_f32 v219, v59, v219
    v_cvt_pk_bf16_f32 v216, v216, v217
    v_cvt_pk_bf16_f32 v217, v218, v219
    v_mul_f32 v220, v60, v220
    v_mul_f32 v221, v61, v221
    v_mul_f32 v222, v62, v222
    v_mul_f32 v223, v63, v223
    v_cvt_pk_bf16_f32 v218, v220, v221
    v_cvt_pk_bf16_f32 v219, v222, v223
    ds_write_b128 v34, v[216:219] offset:14336
    v_mul_f32 v248, v88, v248
    v_mul_f32 v249, v89, v249
    v_mul_f32 v250, v90, v250
    v_mul_f32 v251, v91, v251
    v_cvt_pk_bf16_f32 v248, v248, v249
    v_cvt_pk_bf16_f32 v249, v250, v251
    v_mul_f32 v252, v92, v252
    v_mul_f32 v253, v93, v253
    v_mul_f32 v254, v94, v254
    v_mul_f32 v255, v95, v255
    v_cvt_pk_bf16_f32 v250, v252, v253
    v_cvt_pk_bf16_f32 v251, v254, v255
    ds_write_b128 v35, v[248:251] offset:14336
    ds_read_b128 a[216:219], v36 offset:14336
    ds_read_b128 a[68:71], v36 offset:15360
    s_waitcnt lgkmcnt(9)
    global_store_dwordx4 v28, a[80:83], s[42:43] offset:128 nt
    s_waitcnt lgkmcnt(8)
    global_store_dwordx4 v37, a[244:247], s[42:43] offset:128 nt
    s_waitcnt lgkmcnt(5)
    global_store_dwordx4 v28, a[148:151], s[44:45] offset:128 nt
    s_waitcnt lgkmcnt(4)
    global_store_dwordx4 v37, a[128:131], s[44:45] offset:128 nt
    s_waitcnt lgkmcnt(1)
    global_store_dwordx4 v28, a[216:219], s[46:47] offset:128 nt
    s_waitcnt lgkmcnt(0)
    global_store_dwordx4 v37, a[68:71], s[46:47] offset:128 nt
    s_endpgm
L_SLOWB:
    s_mov_b32 s3, 400
L_POLLB:
    s_sleep 2
    buffer_load_dword v30, off, s[4:7], 0 offset:128 sc1
    s_waitcnt vmcnt(0)
    v_cmp_ne_u32 vcc, s80, v30
    s_nop 1
    s_cbranch_vccz L_FASTB
    s_sub_u32 s3, s3, 1
    s_cmp_lg_u32 s3, 0
    s_cbranch_scc1 L_POLLB
    s_mul_i32 s31, s2, 0xb0000
    s_add_u32 s31, s31, 0x400000
    s_add_u32 s24, s24, s31
    s_addc_u32 s25, s25, 0
    s_add_u32 s20, s20, s31
    s_addc_u32 s21, s21, 0
    s_mov_b32 s22, 626688
    s_mov_b32 s72, 0
L_CLOOP:
    s_add_u32 s3, s72, 8
    s_lshr_b32 s62, s3, 5
    s_bfe_u32 s64, s3, 0x30002
    s_and_b32 s3, s3, 3
    s_xor_b32 s69, s28, s3
    s_lshr_b32 s70, s64, 1
    s_and_b32 s71, s64, 1
    s_lshl_b32 s65, s70, 7
    s_lshl_b32 s66, s71, 4
    s_add_u32 s65, s65, s66
    s_add_u32 s65, s65, s69
    s_lshl_b32 s69, s69, 2
    s_lshl_b32 s71, s71, 6
    s_add_u32 s69, s69, s71
    s_add_u32 s69, s69, s70
    s_add_u32 s70, s62, 1
    s_lshr_b32 s70, s70, 1
    s_lshl_b32 s70, s70, 2
    s_add_u32 s70, s70, s28
    s_lshl_b32 s70, s70, 9
    s_bitcmp1_b32 s62, 0
    s_cselect_b32 s65, s69, s65
    s_cselect_b32 s66, 10, 8
    s_add_u32 s65, s65, s70
    s_lshl_b32 s65, s65, 6
    s_bitcmp1_b32 s62, 0
    s_cselect_b32 s16, s52, s50
    s_cselect_b32 s17, s53, s51
    v_subrev_u32 v30, s32, v24
    v_bfe_u32 v29, v30, 4, 4
    v_and_b32 v30, 12, v29
    v_add_u32 v29, v29, v30
    v_lshlrev_b32 v29, s66, v29
    v_subrev_u32 v30, s32, v24
    v_lshrrev_b32 v30, 4, v30
    v_and_b32 v30, 0x30, v30
    v_add_u32 v29, v29, v30
    buffer_load_dwordx4 a[252:255], v29, s[16:19], s65 offen
    v_subrev_u32 v30, s32, v24
    s_mul_i32 s3, s28, 156672
    s_lshl_b32 s31, s72, 10
    s_add_u32 s3, s3, s31
    s_waitcnt vmcnt(0)
    buffer_store_dwordx4 a[252:255], v30, s[20:23], s3 offen
    s_waitcnt vmcnt(0)
    s_add_u32 s72, s72, 1
    s_cmp_lt_u32 s72, 152
    s_cbranch_scc1 L_CLOOP
    s_mov_b64 vcc, 0
    s_branch L_FASTB
L_END:
s_endpgm
.section .rodata,"a"
.p2align 6
.amdhsa_kernel standalone__cross_network_dcn_v2__recsys_kernel
  .amdhsa_next_free_vgpr 512
  .amdhsa_next_free_sgpr 102
  .amdhsa_accum_offset 256
  .amdhsa_group_segment_fixed_size 0
  .amdhsa_kernarg_size 56
  .amdhsa_user_sgpr_count 2
  .amdhsa_user_sgpr_kernarg_segment_ptr 1
  .amdhsa_system_sgpr_workgroup_id_x 1
.end_amdhsa_kernel
```
